```python
import torch

def _softmax(x, axis=-1):
    return torch.softmax(x, dim=axis)
def _gelu(x):
    return torch.nn.functional.gelu(x, approximate="tanh")
def _silu(x):
    return torch.nn.functional.silu(x)
def _sigmoid(x):
    return torch.sigmoid(x)
def _layernorm(x, axis=-1, eps=1e-5):
    m = x.mean(dim=axis, keepdim=True)
    v = x.var(dim=axis, keepdim=True, unbiased=False)
    return (x - m) / torch.sqrt(v + eps)
def _scatter_add(tgt, idx, src, axis=0):
    return tgt.clone().index_add_(axis, idx, src)
def _segment_sum(src, seg, n):
    out = torch.zeros((n,) + src.shape[1:], dtype=src.dtype)
    return out.index_add_(0, seg, src)
def _pad(x, pw):
    flat = tuple(v for pair in reversed(pw) for v in pair)
    return torch.nn.functional.pad(x, flat)

kernel_name = 'gated_mix__grouped_kv_mqa__mixer_token_mlp__prompt'

def setup_inputs():

    _w = (lambda a: (lambda t: t.to(torch.bfloat16) if t.is_floating_point() else t)(torch.as_tensor(a)))
    def _A_setup():
        B, S, D, H = 1, 2048, 512, 32
        Dh = D // H
        return {
            "x": _w((lambda *s: torch.randn(*s, dtype=torch.bfloat16) * 0.05)(B, S, D)),
            "wq": _w((lambda *s: torch.randn(*s, dtype=torch.bfloat16) * 0.8)(D, H * Dh)),
            "wk": _w((lambda *s: torch.randn(*s, dtype=torch.bfloat16) * 0.8)(D, Dh)),
            "wv": _w((lambda *s: torch.randn(*s, dtype=torch.bfloat16) * 0.05)(D, Dh)),
            "wo": _w((lambda *s: torch.randn(*s, dtype=torch.bfloat16) * 0.05)(H * Dh, D)),
        }
    _A_in = _A_setup()

    def _B_setup():
        B, S, D, F = 1, 2048, 512, 1792
        return {
            "x": _w((lambda *s: torch.randn(*s, dtype=torch.bfloat16) * 0.05)(B, S, D)),
            "w1": _w((lambda *s: torch.randn(*s, dtype=torch.bfloat16) * 0.2)(S, F) * (S ** -0.5)),
            "b1": _w((lambda *s: torch.randn(*s, dtype=torch.bfloat16) * 1.6)(F) * 0.02),
            "w2": _w((lambda *s: torch.randn(*s, dtype=torch.bfloat16) * 0.05)(F, S) * (F ** -0.5)),
            "b2": _w((lambda *s: torch.randn(*s, dtype=torch.bfloat16) * 0.1)(S) * 0.02),
        }
    _B_in = _B_setup()

    return {
        "A_x": _A_in["x"],
        "A_wq": _A_in["wq"],
        "A_wk": _A_in["wk"],
        "A_wv": _A_in["wv"],
        "A_wo": _A_in["wo"],
        "B_x": _B_in["x"],
        "B_w1": _B_in["w1"],
        "B_b1": _B_in["b1"],
        "B_w2": _B_in["w2"],
        "B_b2": _B_in["b2"],
        "gate_w": _w((lambda *s: torch.randn(*s, dtype=torch.bfloat16) * 0.05)(512) * 16.0),
    }

def reference(A_x, A_wq, A_wk, A_wv, A_wo, B_x, B_w1, B_b1, B_w2, B_b2, gate_w):
    def _A_ref(x, wq, wk, wv, wo):
        B, S, D = x.shape
        H = 32
        Dh = D // H
        q = (lambda x, *d: x.permute(*d))((x @ wq).reshape(B, S, H, Dh), 0, 2, 1, 3)
        k = x @ wk
        v = x @ wv
        scores = torch.einsum("bhqd,bkd->bhqk", q, k) * (Dh ** -0.5)
        p = _softmax(scores, axis=-1)
        o = torch.einsum("bhqk,bkd->bhqd", p, v)
        return (lambda x, *d: x.permute(*d))(o, 0, 2, 1, 3).reshape(B, S, H * Dh) @ wo

    def _B_ref(x, w1, b1, w2, b2):
        B, S, D = x.shape
        h = _layernorm(x, axis=-1)
        u = torch.einsum("bsd,sf->bdf", h, w1) + b1
        u = _gelu(u)
        y = torch.einsum("bdf,fs->bds", u, w2) + b2
        return (lambda x, *d: x.permute(*d))(y, 0, 2, 1)

    x = A_x
    g = _sigmoid((x * gate_w).sum(-1, keepdims=True))
    a = _A_ref(x, A_wq, A_wk, A_wv, A_wo)
    b = _B_ref(x, B_w1, B_b1, B_w2, B_b2)
    return g * a + (1 - g) * b
```

```asm
; @launch grid=(256,1,1) block=(768,1,1) lds=160384
.amdgcn_target "amdgcn-amd-amdhsa--gfx950"
.text
.globl gated_mix__grouped_kv_mqa__mixer_token_mlp__prompt_kernel
.p2align 8
.type gated_mix__grouped_kv_mqa__mixer_token_mlp__prompt_kernel,@function
gated_mix__grouped_kv_mqa__mixer_token_mlp__prompt_kernel:
    s_cmp_ge_u32 s2, 256
    s_cbranch_scc1 K_end
    s_load_dwordx8 s[12:19], s[0:1], 0
    s_load_dwordx2 s[8:9], s[0:1], 104
    s_load_dwordx2 s[76:77], s[0:1], 80
    s_load_dwordx2 s[4:5], s[0:1], 96
    v_lshrrev_b32 v1, 6, v0
    v_and_b32 v0, 63, v0
    s_and_b32 s21, s2, 7
    v_readfirstlane_b32 s20, v1
    s_lshr_b32 s22, s2, 3
    s_mov_b32 s60, 65536
    s_mov_b32 s10, 0x1000000
    s_mov_b32 s11, 0x20000
    s_cmp_ge_u32 s20, 4
    s_cbranch_scc1 K_notln
    s_getpc_b64 s[64:65]
K_pc:
    s_sub_u32 s64, s64, K_pc-gated_mix__grouped_kv_mqa__mixer_token_mlp__prompt_kernel
    s_subb_u32 s65, s65, 0
    v_lshrrev_b32 v68, 4, v0
    v_lshl_add_u32 v68, v68, 2, v1
    v_lshl_add_u32 v68, v68, 5, s22
    v_lshlrev_b32 v68, 7, v68
    v_min_u32 v68, K_last-gated_mix__grouped_kv_mqa__mixer_token_mlp__prompt_kernel, v68
    v_mov_b32 v69, 0
    v_lshl_add_u64 v[68:69], v[68:69], 0, s[64:65]
    global_load_dword v48, v[68:69], off
    s_setprio 3
    v_lshrrev_b32 v53, 5, v0
    v_lshl_add_u32 v53, v1, 1, v53
    v_and_b32 v54, 31, v0
    v_lshlrev_b32 v54, 4, v54
    v_lshl_add_u32 v56, v53, 10, v54
    s_lshl_b32 s73, s21, 5
    s_add_u32 s73, s73, s22
    s_lshl_b32 s3, s73, 13
    s_mov_b32 s78, 1024
    s_mov_b32 s79, 0x20000
    s_or_b32 s33, s22, s20
    s_waitcnt lgkmcnt(0)
    s_cbranch_scc0 K_clear
K_clear_done:
    s_mov_b32 s14, 2097152
    s_mov_b32 s15, 0x20000
    buffer_load_dwordx4 v[16:19], v56, s[12:15], s3 offen
    buffer_load_dwordx4 v[20:23], v56, s[12:15], s3 offen offset:512
    buffer_load_dwordx4 v[24:27], v54, s[76:79], 0 offen
    buffer_load_dwordx4 v[28:31], v54, s[76:79], 0 offen offset:512
    s_branch K_gemm
K_clear:
    v_lshlrev_b32 v32, 5, v0
    v_mov_b32 v36, 0
    v_mov_b32 v37, 0
    v_mov_b32 v38, 0
    s_lshl_b32 s33, s2, 10
    s_add_u32 s33, s33, 10092544
    s_lshl_b32 s34, s2, 8
    s_add_u32 s34, s34, 10121216
    s_sub_u32 s34, s34, s33
    s_mov_b32 exec_lo, 0
    v_lshl_add_u32 v32, v0, 7, s34
    s_mov_b32 exec_lo, -1
    s_mov_b32 exec_hi, 3
    buffer_store_dwordx3 v[36:38], v32, s[8:11], s33 offen sc1
    s_mov_b32 exec_hi, -1
    s_branch K_clear_done
K_notln:
    s_sub_u32 s20, s20, 4
    s_lshl_b32 s44, s21, 2
    s_lshr_b32 s46, s22, 3
    s_add_u32 s44, s44, s46
    s_lshl_b32 s46, s46, 1
    s_and_b32 s45, s22, 7
    s_cmp_lg_u32 s20, 0
    s_cbranch_scc1 K_not0
    v_lshrrev_b32 v153, 3, v0
    v_and_b32 v154, 7, v0
    v_lshrrev_b32 v155, 4, v0
    v_xor_b32 v154, v154, v155
    v_lshlrev_b32 v154, 4, v154
    v_lshl_add_u32 v148, v153, 10, v154
    v_xor_b32 v149, 64, v148
    v_add_u32 v149, 7168, v149
    s_mov_b32 s66, 2097152
    s_mov_b32 s67, 0x20000
    s_lshr_b32 s74, s45, 1
    s_lshl_b32 s75, s44, 16
    s_lshl_b32 s73, s46, 7
    s_xor_b32 s72, s74, 0
    s_lshl_b32 s68, s72, 11
    s_lshl_b32 s72, s72, 14
    s_add_u32 s56, s72, s75
    v_lshlrev_b32 v152, 4, v0
    v_mov_b32 v153, 156160
    v_mov_b32 v154, 1
    s_setprio 2
    s_waitcnt lgkmcnt(0)
    s_mov_b32 s64, s12
    s_mov_b32 s65, s13
    s_bitcmp1_b32 s45, 0
    s_cselect_b32 s12, s18, s16
    s_cselect_b32 s13, s19, s17
    s_mov_b32 s14, 16384
    s_mov_b32 s15, 0x20000
    s_add_u32 s72, s46, 0
    s_and_b32 s72, s72, 7
    s_mov_b32 m0, 131072
    s_lshl_b32 s72, s72, 11
    buffer_load_dwordx4 v152, s[12:15], s72 offen offset:0 lds
    buffer_load_dwordx4 v152, s[12:15], s72 offen offset:1024 lds
    buffer_load_dwordx4 v152, s[12:15], s72 offen offset:2048 lds
    buffer_load_dwordx4 v152, s[12:15], s72 offen offset:3072 lds
    s_add_u32 s72, s46, 2
    s_and_b32 s72, s72, 7
    s_mov_b32 m0, 135168
    s_lshl_b32 s72, s72, 11
    buffer_load_dwordx4 v152, s[12:15], s72 offen offset:0 lds
    buffer_load_dwordx4 v152, s[12:15], s72 offen offset:1024 lds
    buffer_load_dwordx4 v152, s[12:15], s72 offen offset:2048 lds
    buffer_load_dwordx4 v152, s[12:15], s72 offen offset:3072 lds
    s_add_u32 s72, s46, 4
    s_and_b32 s72, s72, 7
    s_mov_b32 m0, 139264
    s_lshl_b32 s72, s72, 11
    buffer_load_dwordx4 v152, s[12:15], s72 offen offset:0 lds
    buffer_load_dwordx4 v152, s[12:15], s72 offen offset:1024 lds
    buffer_load_dwordx4 v152, s[12:15], s72 offen offset:2048 lds
    buffer_load_dwordx4 v152, s[12:15], s72 offen offset:3072 lds
    s_add_u32 s72, s46, 6
    s_and_b32 s72, s72, 7
    s_mov_b32 m0, 143360
    s_lshl_b32 s72, s72, 11
    buffer_load_dwordx4 v152, s[12:15], s72 offen offset:0 lds
    buffer_load_dwordx4 v152, s[12:15], s72 offen offset:1024 lds
    buffer_load_dwordx4 v152, s[12:15], s72 offen offset:2048 lds
    buffer_load_dwordx4 v152, s[12:15], s72 offen offset:3072 lds
    s_add_u32 m0, s68, 0
    s_add_u32 s72, s56, s73
    buffer_load_dwordx4 v148, s[64:67], s72 offen lds
    buffer_load_dwordx4 v149, s[64:67], s72 offen offset:1024 lds
    s_add_u32 s73, s73, 128
    s_and_b32 s73, s73, 1023
    s_add_u32 m0, s68, 8192
    s_add_u32 s72, s56, s73
    buffer_load_dwordx4 v148, s[64:67], s72 offen lds
    buffer_load_dwordx4 v149, s[64:67], s72 offen offset:1024 lds
    s_add_u32 s73, s73, 128
    s_and_b32 s73, s73, 1023
    s_add_u32 m0, s68, 16384
    s_add_u32 s72, s56, s73
    buffer_load_dwordx4 v148, s[64:67], s72 offen lds
    buffer_load_dwordx4 v149, s[64:67], s72 offen offset:1024 lds
    s_add_u32 s73, s73, 128
    s_and_b32 s73, s73, 1023
    s_add_u32 m0, s68, 24576
    s_add_u32 s72, s56, s73
    buffer_load_dwordx4 v148, s[64:67], s72 offen lds
    buffer_load_dwordx4 v149, s[64:67], s72 offen offset:1024 lds
    s_add_u32 s73, s73, 128
    s_and_b32 s73, s73, 1023
    s_add_u32 m0, s68, 40960
    s_add_u32 s72, s56, s73
    buffer_load_dwordx4 v148, s[64:67], s72 offen lds
    buffer_load_dwordx4 v149, s[64:67], s72 offen offset:1024 lds
    s_add_u32 s73, s73, 128
    s_and_b32 s73, s73, 1023
    s_add_u32 m0, s68, 49152
    s_add_u32 s72, s56, s73
    buffer_load_dwordx4 v148, s[64:67], s72 offen lds
    buffer_load_dwordx4 v149, s[64:67], s72 offen offset:1024 lds
    s_add_u32 s73, s73, 128
    s_and_b32 s73, s73, 1023
    s_add_u32 m0, s68, 32768
    s_add_u32 s72, s56, s73
    buffer_load_dwordx4 v148, s[64:67], s72 offen lds
    buffer_load_dwordx4 v149, s[64:67], s72 offen offset:1024 lds
    s_add_u32 s73, s73, 128
    s_and_b32 s73, s73, 1023
    s_add_u32 m0, s68, 57344
    s_add_u32 s72, s56, s73
    buffer_load_dwordx4 v148, s[64:67], s72 offen lds
    buffer_load_dwordx4 v149, s[64:67], s72 offen offset:1024 lds
    s_add_u32 s73, s73, 128
    s_and_b32 s73, s73, 1023
    s_barrier
    s_mov_b64 exec, 1
    s_waitcnt vmcnt(0)
    ds_add_u32 v153, v154 offset:76
    s_mov_b64 exec, -1
    s_setprio 0
    s_branch K_cleared
K_not0:
    s_cmp_eq_u32 s20, 1
    s_cbranch_scc1 K_loadw
    s_cmp_eq_u32 s20, 7
    s_cbranch_scc1 K_loadx
    s_cmp_eq_u32 s20, 6
    s_cbranch_scc1 K_kv
    s_barrier
K_cleared:
    s_mul_i32 s33, s21, 28
    s_add_u32 s33, s33, s22
    s_and_b32 s32, s33, 7
    s_lshr_b32 s33, s33, 3
    s_lshl_b32 s50, s32, 1
    s_and_b32 s31, s20, 1
    s_add_u32 s50, s50, s31
    s_mul_i32 s50, s50, 112
    s_lshl_b32 s35, s33, 2
    s_add_u32 s50, s50, s35
    s_and_b32 s35, s20, 2
    s_add_u32 s50, s50, s35
    s_lshl_b32 s50, s50, 10
    s_add_u32 s50, s50, 6291456
    s_and_b32 s23, s20, 3
    s_lshr_b32 s29, s20, 2
    s_lshl_b32 s28, s23, 1
    s_add_u32 s28, s28, s29
    s_lshl_b32 s41, s21, 2
    s_add_u32 s41, s41, s23
    s_lshl_b32 s41, s41, 1
    s_add_u32 s41, s41, s29
    s_lshl_b32 s37, s23, 8
    s_add_u32 s37, s37, 10092544
    v_lshrrev_b32 v2, 3, v0
    v_lshlrev_b32 v2, 5, v2
    v_and_b32 v140, 7, v0
    v_add_u32 v2, v2, v140
    v_lshlrev_b32 v167, 5, v2
    s_lshl_b32 s41, s41, 11
    s_add_u32 s41, s41, 8388608
    s_lshl_b32 s40, s28, 10
    s_xor_b32 s30, s40, 1024
    s_add_u32 s40, s40, 90112
    s_add_u32 s30, s30, 90112
    v_lshlrev_b32 v1, 4, v0
    s_lshl_b32 s51, s44, 3
    s_add_u32 s51, s51, s45
    s_lshl_b32 s51, s51, 5
    s_add_u32 s51, s51, 10092544
    v_mov_b32 v165, 156160
    v_bfe_u32 v140, v0, 2, 3
    v_min_u32 v166, 6, v140
    s_mul_i32 s35, s23, 56
    s_add_u32 s35, s35, s45
    v_lshl_add_u32 v166, v166, 3, s35
    v_mul_u32_u24 v141, 2341, v166
    v_lshrrev_b32 v141, 16, v141
    v_lshl_add_u32 v166, v141, 2, v166
    s_lshl_b32 s35, s44, 3
    v_cmp_gt_u32 vcc, 32, v0
    v_add_u32 v140, s35, v140
    s_mov_b32 s52, 10092552
    v_cndmask_b32 v166, v140, v166, vcc
    v_lshlrev_b32 v166, 5, v166
    s_lshl_b32 s35, s44, 1
    s_add_u32 s35, s35, s31
    s_lshl_b32 s34, s35, 7
    s_add_u32 s34, s34, 8650752
    v_and_b32 v8, 31, v0
    v_lshlrev_b32 v8, 2, v8
    s_lshl_b32 s49, s35, 3
    s_add_u32 s49, s49, s45
    s_lshl_b32 s49, s49, 2
    s_lshr_b32 s35, s20, 1
    s_add_u32 s49, s49, s35
    s_lshl_b32 s49, s49, 10
    s_add_u32 s49, s49, 4194304
    s_mul_i32 s35, s29, 146048
    s_add_u32 s35, s35, 10240
    v_add_u32 v158, s35, v1
    v_lshrrev_b32 v141, 5, v0
    v_and_b32 v140, 15, v0
    v_lshlrev_b32 v140, 4, v140
    v_lshl_add_u32 v140, v141, 8, v140
    v_add_u32 v3, s40, v140
    v_add_u32 v4, s30, v140
    v_add_u32 v6, s30, v1
    v_lshl_add_u32 v7, v0, 2, s30
    s_lshl_b32 s35, s20, 2
    s_add_u32 s36, s35, 156192
    s_xor_b32 s35, s35, 16
    s_add_u32 s35, s35, 156192
    v_mov_b32 v9, s36
    v_mov_b32 v10, s35
    v_mov_b32 v11, 1
    v_mov_b32 v5, 0xdddddddd
    s_mov_b32 s42, 0xffff
    s_mov_b32 s43, 0xffff
    v_and_b32 v140, 27, v0
    v_cmp_eq_u32 vcc, 16, v140
    v_mov_b32 v141, 0x3f803f80
    v_mov_b32 v156, -1
    v_cndmask_b32 v124, 0, v141, vcc
    v_mov_b32 v125, v124
    v_mov_b32 v126, v124
    v_mov_b32 v127, v124
    v_mov_b32 v128, v124
    v_mov_b32 v129, v124
    v_mov_b32 v130, v124
    v_mov_b32 v131, v124
    v_mov_b32 v132, v124
    v_mov_b32 v133, v124
    v_mov_b32 v134, v124
    v_mov_b32 v135, v124
    v_mov_b32 v136, v124
    v_mov_b32 v137, v124
    v_mov_b32 v138, v124
    v_mov_b32 v139, v124
    v_mov_b32 v12, 0
    v_mov_b32 v13, 0
    v_mov_b32 v14, 0
    v_mov_b32 v15, 0
    v_mov_b32 v16, 0
    v_mov_b32 v17, 0
    v_mov_b32 v18, 0
    v_mov_b32 v19, 0
    v_mov_b32 v20, 0
    v_mov_b32 v21, 0
    v_mov_b32 v22, 0
    v_mov_b32 v23, 0
    v_mov_b32 v24, 0
    v_mov_b32 v25, 0
    v_mov_b32 v26, 0
    v_mov_b32 v27, 0
    v_mov_b32 v28, 0
    v_mov_b32 v29, 0
    v_mov_b32 v30, 0
    v_mov_b32 v31, 0
    v_mov_b32 v32, 0
    v_mov_b32 v33, 0
    v_mov_b32 v34, 0
    v_mov_b32 v35, 0
    v_mov_b32 v36, 0
    v_mov_b32 v37, 0
    v_mov_b32 v38, 0
    v_mov_b32 v39, 0
    v_mov_b32 v40, 0
    v_mov_b32 v41, 0
    v_mov_b32 v42, 0
    v_mov_b32 v43, 0
    v_mov_b32 v44, 0
    v_mov_b32 v45, 0
    v_mov_b32 v46, 0
    v_mov_b32 v47, 0
    v_mov_b32 v48, 0
    v_mov_b32 v49, 0
    v_mov_b32 v50, 0
    v_mov_b32 v51, 0
    v_mov_b32 v52, 0
    v_mov_b32 v53, 0
    v_mov_b32 v54, 0
    v_mov_b32 v55, 0
    v_mov_b32 v56, 0
    v_mov_b32 v57, 0
    v_mov_b32 v58, 0
    v_mov_b32 v59, 0
    v_mov_b32 v60, 0
    v_mov_b32 v61, 0
    v_mov_b32 v62, 0
    v_mov_b32 v63, 0
    v_mov_b32 v64, 0
    v_mov_b32 v65, 0
    v_mov_b32 v66, 0
    v_mov_b32 v67, 0
    v_mov_b32 v68, 0
    v_mov_b32 v69, 0
    v_mov_b32 v70, 0
    v_mov_b32 v71, 0
    v_mov_b32 v72, 0
    v_mov_b32 v73, 0
    v_mov_b32 v74, 0
    v_mov_b32 v75, 0
    s_sub_u32 s36, s23, 1
    s_and_b32 s36, s36, 3
    s_sub_u32 s36, s36, s23
    s_lshl_b32 s36, s36, 11
    v_add_u32 v159, s36, v6
    v_add_u32 v160, s36, v7
    s_sub_u32 s36, s23, 2
    s_and_b32 s36, s36, 3
    s_sub_u32 s36, s36, s23
    s_lshl_b32 s36, s36, 11
    v_add_u32 v161, s36, v6
    v_add_u32 v162, s36, v7
    s_sub_u32 s36, s23, 3
    s_and_b32 s36, s36, 3
    s_sub_u32 s36, s36, s23
    s_lshl_b32 s36, s36, 11
    v_add_u32 v163, s36, v6
    v_add_u32 v164, s36, v7
    s_and_b32 s35, s20, 4
    s_add_u32 s35, s35, 156168
    v_mov_b32 v157, s35
    s_mov_b32 s53, 0x2b800000
    s_mov_b32 s54, 0x28000000
    s_add_u32 s28, s23, 1
    s_and_b32 s28, s28, 3
    s_lshl_b32 s28, s28, 10
    s_add_u32 s29, s23, 2
    s_and_b32 s29, s29, 3
    s_lshl_b32 s29, s29, 10
    s_add_u32 s30, s23, 3
    s_and_b32 s30, s30, 3
    s_lshl_b32 s30, s30, 10
    s_add_u32 s31, s23, 4
    s_and_b32 s31, s31, 3
    s_lshl_b32 s31, s31, 10
    s_cmp_eq_u32 s20, 6
    s_cbranch_scc1 K_kv3
    s_sub_u32 s33, s20, 2
    s_cmp_lt_u32 s33, 4
    s_cbranch_scc1 K_q
K_idle:
    s_barrier
    s_setprio 3
    s_xor_b32 s25, s41, 0
    buffer_load_dwordx4 v[140:143], v1, s[8:11], s25 offen sc1
    s_add_u32 m0, s40, 40960
    s_xor_b32 s27, s41, 1024
    buffer_load_dwordx4 v1, s[8:11], s27 offen sc1 lds
    s_xor_b32 s25, s41, 2048
    buffer_load_dwordx4 v[144:147], v1, s[8:11], s25 offen sc1
    s_branch K_att
K_loadw:
    v_lshrrev_b32 v153, 3, v0
    v_and_b32 v154, 7, v0
    v_bfe_u32 v155, v0, 4, 1
    v_lshlrev_b32 v155, 2, v155
    v_xor_b32 v154, v154, v155
    v_lshlrev_b32 v154, 4, v154
    v_lshl_add_u32 v148, v153, 10, v154
    v_add_u32 v149, 7168, v148
    v_add_u32 v150, 14336, v148
    v_add_u32 v151, 21504, v148
    s_lshl_b32 s74, s45, 7
    s_mov_b32 s73, s46
    s_mov_b32 s66, 524288
    s_mov_b32 s67, 0x20000
    s_waitcnt lgkmcnt(0)
    s_mov_b32 s64, s14
    s_mov_b32 s65, s15
    v_mov_b32 v165, 156160
    v_mov_b32 v11, 1
    s_barrier
    s_lshl_b32 s72, s73, 16
    s_mov_b32 m0, 65536
    s_add_u32 s72, s72, s74
    buffer_load_dwordx4 v148, s[64:67], s72 offen offset:0 lds
    buffer_load_dwordx4 v149, s[64:67], s72 offen offset:1024 lds
    buffer_load_dwordx4 v150, s[64:67], s72 offen offset:2048 lds
    buffer_load_dwordx4 v151, s[64:67], s72 offen offset:3072 lds
    s_mov_b32 m0, 69632
    s_add_u32 s72, s72, 32768
    buffer_load_dwordx4 v148, s[64:67], s72 offen offset:0 lds
    buffer_load_dwordx4 v149, s[64:67], s72 offen offset:1024 lds
    buffer_load_dwordx4 v150, s[64:67], s72 offen offset:2048 lds
    buffer_load_dwordx4 v151, s[64:67], s72 offen offset:3072 lds
    s_add_u32 s73, s73, 1
    s_and_b32 s73, s73, 7
    s_lshl_b32 s72, s73, 16
    s_mov_b32 m0, 73728
    s_add_u32 s72, s72, s74
    buffer_load_dwordx4 v148, s[64:67], s72 offen offset:0 lds
    buffer_load_dwordx4 v149, s[64:67], s72 offen offset:1024 lds
    buffer_load_dwordx4 v150, s[64:67], s72 offen offset:2048 lds
    buffer_load_dwordx4 v151, s[64:67], s72 offen offset:3072 lds
    s_mov_b32 m0, 77824
    s_add_u32 s72, s72, 32768
    buffer_load_dwordx4 v148, s[64:67], s72 offen offset:0 lds
    buffer_load_dwordx4 v149, s[64:67], s72 offen offset:1024 lds
    buffer_load_dwordx4 v150, s[64:67], s72 offen offset:2048 lds
    buffer_load_dwordx4 v151, s[64:67], s72 offen offset:3072 lds
    s_add_u32 s73, s73, 1
    s_and_b32 s73, s73, 7
    s_mul_i32 s33, s21, 28
    s_add_u32 s33, s33, s22
    s_and_b32 s32, s33, 7
    s_lshr_b32 s33, s33, 3
    s_lshl_b32 s50, s32, 1
    s_and_b32 s31, s20, 1
    s_add_u32 s50, s50, s31
    s_mul_i32 s50, s50, 112
    s_lshl_b32 s35, s33, 2
    s_add_u32 s50, s50, s35
    s_and_b32 s35, s20, 2
    s_add_u32 s50, s50, s35
    s_lshl_b32 s50, s50, 10
    s_add_u32 s50, s50, 6291456
    s_and_b32 s23, s20, 3
    s_lshr_b32 s29, s20, 2
    s_lshl_b32 s28, s23, 1
    s_add_u32 s28, s28, s29
    s_lshl_b32 s41, s21, 2
    s_add_u32 s41, s41, s23
    s_lshl_b32 s41, s41, 1
    s_add_u32 s41, s41, s29
    s_lshl_b32 s37, s23, 8
    s_add_u32 s37, s37, 10092544
    v_lshrrev_b32 v2, 3, v0
    v_lshlrev_b32 v2, 5, v2
    v_and_b32 v140, 7, v0
    v_add_u32 v2, v2, v140
    v_lshlrev_b32 v167, 5, v2
    s_lshl_b32 s41, s41, 11
    s_add_u32 s41, s41, 8388608
    s_lshl_b32 s40, s28, 10
    s_xor_b32 s30, s40, 1024
    s_add_u32 s40, s40, 90112
    s_add_u32 s30, s30, 90112
    v_lshlrev_b32 v1, 4, v0
    s_lshl_b32 s51, s44, 3
    s_add_u32 s51, s51, s45
    s_lshl_b32 s51, s51, 5
    s_add_u32 s51, s51, 10092544
    v_mov_b32 v165, 156160
    v_bfe_u32 v140, v0, 2, 3
    v_min_u32 v166, 6, v140
    s_mul_i32 s35, s23, 56
    s_add_u32 s35, s35, s45
    v_lshl_add_u32 v166, v166, 3, s35
    v_mul_u32_u24 v141, 2341, v166
    v_lshrrev_b32 v141, 16, v141
    v_lshl_add_u32 v166, v141, 2, v166
    s_lshl_b32 s35, s44, 3
    v_cmp_gt_u32 vcc, 32, v0
    v_add_u32 v140, s35, v140
    s_mov_b32 s52, 10092552
    v_cndmask_b32 v166, v140, v166, vcc
    v_lshlrev_b32 v166, 5, v166
    s_lshl_b32 s35, s44, 1
    s_add_u32 s35, s35, s31
    s_lshl_b32 s34, s35, 7
    s_add_u32 s34, s34, 8650752
    v_and_b32 v8, 31, v0
    v_lshlrev_b32 v8, 2, v8
    s_lshl_b32 s49, s35, 3
    s_add_u32 s49, s49, s45
    s_lshl_b32 s49, s49, 2
    s_lshr_b32 s35, s20, 1
    s_add_u32 s49, s49, s35
    s_lshl_b32 s49, s49, 10
    s_add_u32 s49, s49, 4194304
    s_mul_i32 s35, s29, 146048
    s_add_u32 s35, s35, 10240
    v_add_u32 v158, s35, v1
    v_lshrrev_b32 v141, 5, v0
    v_and_b32 v140, 15, v0
    v_lshlrev_b32 v140, 4, v140
    v_lshl_add_u32 v140, v141, 8, v140
    v_add_u32 v3, s40, v140
    v_add_u32 v4, s30, v140
    v_add_u32 v6, s30, v1
    v_lshl_add_u32 v7, v0, 2, s30
    s_lshl_b32 s35, s20, 2
    s_add_u32 s36, s35, 156192
    s_xor_b32 s35, s35, 16
    s_add_u32 s35, s35, 156192
    v_mov_b32 v9, s36
    v_mov_b32 v10, s35
    v_mov_b32 v11, 1
    v_mov_b32 v5, 0xdddddddd
    s_mov_b32 s42, 0xffff
    s_mov_b32 s43, 0xffff
    v_and_b32 v140, 27, v0
    v_cmp_eq_u32 vcc, 16, v140
    v_mov_b32 v141, 0x3f803f80
    v_mov_b32 v156, -1
    v_cndmask_b32 v124, 0, v141, vcc
    v_mov_b32 v125, v124
    v_mov_b32 v126, v124
    v_mov_b32 v127, v124
    v_mov_b32 v128, v124
    v_mov_b32 v129, v124
    v_mov_b32 v130, v124
    v_mov_b32 v131, v124
    v_mov_b32 v132, v124
    v_mov_b32 v133, v124
    v_mov_b32 v134, v124
    v_mov_b32 v135, v124
    v_mov_b32 v136, v124
    v_mov_b32 v137, v124
    v_mov_b32 v138, v124
    v_mov_b32 v139, v124
    v_mov_b32 v12, 0
    s_waitcnt vmcnt(8)
    s_mov_b64 exec, 1
    ds_add_u32 v165, v11 offset:68
    s_mov_b64 exec, -1
    s_lshl_b32 s72, s73, 16
    s_mov_b32 m0, 81920
    s_add_u32 s72, s72, s74
    s_nop 0
    buffer_load_dwordx4 v148, s[64:67], s72 offen offset:0 lds
    buffer_load_dwordx4 v149, s[64:67], s72 offen offset:1024 lds
    buffer_load_dwordx4 v150, s[64:67], s72 offen offset:2048 lds
    buffer_load_dwordx4 v151, s[64:67], s72 offen offset:3072 lds
    s_mov_b32 m0, 86016
    s_add_u32 s72, s72, 32768
    buffer_load_dwordx4 v148, s[64:67], s72 offen offset:0 lds
    buffer_load_dwordx4 v149, s[64:67], s72 offen offset:1024 lds
    buffer_load_dwordx4 v150, s[64:67], s72 offen offset:2048 lds
    buffer_load_dwordx4 v151, s[64:67], s72 offen offset:3072 lds
    s_add_u32 s73, s73, 1
    s_and_b32 s73, s73, 7
    v_mov_b32 v13, 0
    v_mov_b32 v14, 0
    v_mov_b32 v15, 0
    v_mov_b32 v16, 0
    v_mov_b32 v17, 0
    v_mov_b32 v18, 0
    v_mov_b32 v19, 0
    v_mov_b32 v20, 0
    v_mov_b32 v21, 0
    v_mov_b32 v22, 0
    v_mov_b32 v23, 0
    v_mov_b32 v24, 0
    v_mov_b32 v25, 0
    v_mov_b32 v26, 0
    v_mov_b32 v27, 0
    v_mov_b32 v28, 0
    v_mov_b32 v29, 0
    v_mov_b32 v30, 0
    v_mov_b32 v31, 0
    v_mov_b32 v32, 0
    s_waitcnt vmcnt(8)
    s_mov_b64 exec, 1
    ds_add_u32 v165, v11 offset:68
    s_mov_b64 exec, -1
    s_lshl_b32 s72, s73, 16
    s_mov_b32 m0, 90112
    s_add_u32 s72, s72, s74
    s_nop 0
    buffer_load_dwordx4 v148, s[64:67], s72 offen offset:0 lds
    buffer_load_dwordx4 v149, s[64:67], s72 offen offset:1024 lds
    buffer_load_dwordx4 v150, s[64:67], s72 offen offset:2048 lds
    buffer_load_dwordx4 v151, s[64:67], s72 offen offset:3072 lds
    s_mov_b32 m0, 94208
    s_add_u32 s72, s72, 32768
    buffer_load_dwordx4 v148, s[64:67], s72 offen offset:0 lds
    buffer_load_dwordx4 v149, s[64:67], s72 offen offset:1024 lds
    buffer_load_dwordx4 v150, s[64:67], s72 offen offset:2048 lds
    buffer_load_dwordx4 v151, s[64:67], s72 offen offset:3072 lds
    s_add_u32 s73, s73, 1
    s_and_b32 s73, s73, 7
    v_mov_b32 v33, 0
    v_mov_b32 v34, 0
    v_mov_b32 v35, 0
    v_mov_b32 v36, 0
    v_mov_b32 v37, 0
    v_mov_b32 v38, 0
    v_mov_b32 v39, 0
    v_mov_b32 v40, 0
    v_mov_b32 v41, 0
    v_mov_b32 v42, 0
    v_mov_b32 v43, 0
    v_mov_b32 v44, 0
    v_mov_b32 v45, 0
    v_mov_b32 v46, 0
    v_mov_b32 v47, 0
    v_mov_b32 v48, 0
    v_mov_b32 v49, 0
    v_mov_b32 v50, 0
    v_mov_b32 v51, 0
    v_mov_b32 v52, 0
    s_waitcnt vmcnt(8)
    s_mov_b64 exec, 1
    ds_add_u32 v165, v11 offset:68
    s_mov_b64 exec, -1
    s_lshl_b32 s72, s73, 16
    s_mov_b32 m0, 98304
    s_add_u32 s72, s72, s74
    s_nop 0
    buffer_load_dwordx4 v148, s[64:67], s72 offen offset:0 lds
    buffer_load_dwordx4 v149, s[64:67], s72 offen offset:1024 lds
    buffer_load_dwordx4 v150, s[64:67], s72 offen offset:2048 lds
    buffer_load_dwordx4 v151, s[64:67], s72 offen offset:3072 lds
    s_mov_b32 m0, 102400
    s_add_u32 s72, s72, 32768
    buffer_load_dwordx4 v148, s[64:67], s72 offen offset:0 lds
    buffer_load_dwordx4 v149, s[64:67], s72 offen offset:1024 lds
    buffer_load_dwordx4 v150, s[64:67], s72 offen offset:2048 lds
    buffer_load_dwordx4 v151, s[64:67], s72 offen offset:3072 lds
    s_add_u32 s73, s73, 1
    s_and_b32 s73, s73, 7
    v_mov_b32 v53, 0
    v_mov_b32 v54, 0
    v_mov_b32 v55, 0
    v_mov_b32 v56, 0
    v_mov_b32 v57, 0
    v_mov_b32 v58, 0
    v_mov_b32 v59, 0
    v_mov_b32 v60, 0
    v_mov_b32 v61, 0
    v_mov_b32 v62, 0
    v_mov_b32 v63, 0
    v_mov_b32 v64, 0
    v_mov_b32 v65, 0
    v_mov_b32 v66, 0
    v_mov_b32 v67, 0
    v_mov_b32 v68, 0
    v_mov_b32 v69, 0
    v_mov_b32 v70, 0
    v_mov_b32 v71, 0
    v_mov_b32 v72, 0
    s_waitcnt vmcnt(8)
    s_mov_b64 exec, 1
    ds_add_u32 v165, v11 offset:68
    s_mov_b64 exec, -1
    s_lshl_b32 s72, s73, 16
    s_mov_b32 m0, 106496
    s_add_u32 s72, s72, s74
    s_nop 0
    buffer_load_dwordx4 v148, s[64:67], s72 offen offset:0 lds
    buffer_load_dwordx4 v149, s[64:67], s72 offen offset:1024 lds
    buffer_load_dwordx4 v150, s[64:67], s72 offen offset:2048 lds
    buffer_load_dwordx4 v151, s[64:67], s72 offen offset:3072 lds
    s_mov_b32 m0, 110592
    s_add_u32 s72, s72, 32768
    buffer_load_dwordx4 v148, s[64:67], s72 offen offset:0 lds
    buffer_load_dwordx4 v149, s[64:67], s72 offen offset:1024 lds
    buffer_load_dwordx4 v150, s[64:67], s72 offen offset:2048 lds
    buffer_load_dwordx4 v151, s[64:67], s72 offen offset:3072 lds
    s_add_u32 s73, s73, 1
    s_and_b32 s73, s73, 7
    v_mov_b32 v73, 0
    v_mov_b32 v74, 0
    v_mov_b32 v75, 0
    s_sub_u32 s36, s23, 1
    s_and_b32 s36, s36, 3
    s_sub_u32 s36, s36, s23
    s_lshl_b32 s36, s36, 11
    v_add_u32 v159, s36, v6
    v_add_u32 v160, s36, v7
    s_sub_u32 s36, s23, 2
    s_and_b32 s36, s36, 3
    s_sub_u32 s36, s36, s23
    s_lshl_b32 s36, s36, 11
    v_add_u32 v161, s36, v6
    v_add_u32 v162, s36, v7
    s_sub_u32 s36, s23, 3
    s_and_b32 s36, s36, 3
    s_sub_u32 s36, s36, s23
    s_lshl_b32 s36, s36, 11
    v_add_u32 v163, s36, v6
    s_waitcnt vmcnt(8)
    s_mov_b64 exec, 1
    ds_add_u32 v165, v11 offset:68
    s_mov_b64 exec, -1
    s_lshl_b32 s72, s73, 16
    s_mov_b32 m0, 114688
    s_add_u32 s72, s72, s74
    s_nop 0
    buffer_load_dwordx4 v148, s[64:67], s72 offen offset:0 lds
    buffer_load_dwordx4 v149, s[64:67], s72 offen offset:1024 lds
    buffer_load_dwordx4 v150, s[64:67], s72 offen offset:2048 lds
    buffer_load_dwordx4 v151, s[64:67], s72 offen offset:3072 lds
    s_mov_b32 m0, 118784
    s_add_u32 s72, s72, 32768
    buffer_load_dwordx4 v148, s[64:67], s72 offen offset:0 lds
    buffer_load_dwordx4 v149, s[64:67], s72 offen offset:1024 lds
    buffer_load_dwordx4 v150, s[64:67], s72 offen offset:2048 lds
    buffer_load_dwordx4 v151, s[64:67], s72 offen offset:3072 lds
    s_add_u32 s73, s73, 1
    s_and_b32 s73, s73, 7
    v_add_u32 v164, s36, v7
    s_and_b32 s35, s20, 4
    s_add_u32 s35, s35, 156168
    v_mov_b32 v157, s35
    s_mov_b32 s53, 0x2b800000
    s_mov_b32 s54, 0x28000000
    s_add_u32 s28, s23, 1
    s_and_b32 s28, s28, 3
    s_lshl_b32 s28, s28, 10
    s_add_u32 s29, s23, 2
    s_and_b32 s29, s29, 3
    s_lshl_b32 s29, s29, 10
    s_add_u32 s30, s23, 3
    s_and_b32 s30, s30, 3
    s_lshl_b32 s30, s30, 10
    s_add_u32 s31, s23, 4
    s_and_b32 s31, s31, 3
    s_lshl_b32 s31, s31, 10
    s_waitcnt vmcnt(8)
    s_mov_b64 exec, 1
    ds_add_u32 v165, v11 offset:68
    s_mov_b64 exec, -1
    s_lshl_b32 s72, s73, 16
    s_mov_b32 m0, 122880
    s_add_u32 s72, s72, s74
    buffer_load_dwordx4 v148, s[64:67], s72 offen offset:0 lds
    buffer_load_dwordx4 v149, s[64:67], s72 offen offset:1024 lds
    buffer_load_dwordx4 v150, s[64:67], s72 offen offset:2048 lds
    buffer_load_dwordx4 v151, s[64:67], s72 offen offset:3072 lds
    s_mov_b32 m0, 126976
    s_add_u32 s72, s72, 32768
    buffer_load_dwordx4 v148, s[64:67], s72 offen offset:0 lds
    buffer_load_dwordx4 v149, s[64:67], s72 offen offset:1024 lds
    buffer_load_dwordx4 v150, s[64:67], s72 offen offset:2048 lds
    buffer_load_dwordx4 v151, s[64:67], s72 offen offset:3072 lds
    s_add_u32 s73, s73, 1
    s_and_b32 s73, s73, 7
    s_waitcnt vmcnt(8)
    s_mov_b64 exec, 1
    ds_add_u32 v165, v11 offset:68
    s_mov_b64 exec, -1
    s_waitcnt vmcnt(0)
    s_mov_b64 exec, 1
    ds_add_u32 v165, v11 offset:68
    s_mov_b64 exec, -1
    s_branch K_idle
K_loadx:
    v_lshrrev_b32 v153, 3, v0
    v_and_b32 v154, 7, v0
    v_lshrrev_b32 v155, 4, v0
    v_xor_b32 v154, v154, v155
    v_lshlrev_b32 v154, 4, v154
    v_lshl_add_u32 v148, v153, 10, v154
    v_xor_b32 v149, 64, v148
    v_add_u32 v149, 7168, v149
    s_mov_b32 s66, 2097152
    s_mov_b32 s67, 0x20000
    s_lshr_b32 s74, s45, 1
    s_lshl_b32 s75, s44, 16
    s_lshl_b32 s73, s46, 7
    s_xor_b32 s72, s74, 1
    s_lshl_b32 s69, s72, 11
    s_lshl_b32 s72, s72, 14
    s_add_u32 s57, s72, s75
    s_xor_b32 s72, s74, 2
    s_lshl_b32 s70, s72, 11
    s_lshl_b32 s72, s72, 14
    s_add_u32 s58, s72, s75
    s_xor_b32 s72, s74, 3
    s_lshl_b32 s71, s72, 11
    s_lshl_b32 s72, s72, 14
    s_add_u32 s59, s72, s75
    s_waitcnt lgkmcnt(0)
    s_mov_b32 s64, s12
    s_mov_b32 s65, s13
    v_mov_b32 v165, 156160
    v_mov_b32 v11, 1
    s_barrier
    s_add_u32 m0, s69, 0
    s_add_u32 s72, s57, s73
    buffer_load_dwordx4 v148, s[64:67], s72 offen lds
    buffer_load_dwordx4 v149, s[64:67], s72 offen offset:1024 lds
    s_add_u32 m0, s70, 0
    s_add_u32 s72, s58, s73
    buffer_load_dwordx4 v148, s[64:67], s72 offen lds
    buffer_load_dwordx4 v149, s[64:67], s72 offen offset:1024 lds
    s_add_u32 m0, s71, 0
    s_add_u32 s72, s59, s73
    buffer_load_dwordx4 v148, s[64:67], s72 offen lds
    buffer_load_dwordx4 v149, s[64:67], s72 offen offset:1024 lds
    s_add_u32 s73, s73, 128
    s_and_b32 s73, s73, 1023
    s_add_u32 m0, s69, 8192
    s_add_u32 s72, s57, s73
    buffer_load_dwordx4 v148, s[64:67], s72 offen lds
    buffer_load_dwordx4 v149, s[64:67], s72 offen offset:1024 lds
    s_add_u32 m0, s70, 8192
    s_add_u32 s72, s58, s73
    buffer_load_dwordx4 v148, s[64:67], s72 offen lds
    buffer_load_dwordx4 v149, s[64:67], s72 offen offset:1024 lds
    s_add_u32 m0, s71, 8192
    s_add_u32 s72, s59, s73
    buffer_load_dwordx4 v148, s[64:67], s72 offen lds
    buffer_load_dwordx4 v149, s[64:67], s72 offen offset:1024 lds
    s_add_u32 s73, s73, 128
    s_and_b32 s73, s73, 1023
    s_add_u32 m0, s69, 16384
    s_add_u32 s72, s57, s73
    buffer_load_dwordx4 v148, s[64:67], s72 offen lds
    buffer_load_dwordx4 v149, s[64:67], s72 offen offset:1024 lds
    s_add_u32 m0, s70, 16384
    s_add_u32 s72, s58, s73
    buffer_load_dwordx4 v148, s[64:67], s72 offen lds
    buffer_load_dwordx4 v149, s[64:67], s72 offen offset:1024 lds
    s_add_u32 m0, s71, 16384
    s_add_u32 s72, s59, s73
    buffer_load_dwordx4 v148, s[64:67], s72 offen lds
    buffer_load_dwordx4 v149, s[64:67], s72 offen offset:1024 lds
    s_add_u32 s73, s73, 128
    s_and_b32 s73, s73, 1023
    s_mul_i32 s33, s21, 28
    s_add_u32 s33, s33, s22
    s_and_b32 s32, s33, 7
    s_lshr_b32 s33, s33, 3
    s_lshl_b32 s50, s32, 1
    s_and_b32 s31, s20, 1
    s_add_u32 s50, s50, s31
    s_mul_i32 s50, s50, 112
    s_lshl_b32 s35, s33, 2
    s_add_u32 s50, s50, s35
    s_and_b32 s35, s20, 2
    s_add_u32 s50, s50, s35
    s_lshl_b32 s50, s50, 10
    s_add_u32 s50, s50, 6291456
    s_and_b32 s23, s20, 3
    s_lshr_b32 s29, s20, 2
    s_lshl_b32 s28, s23, 1
    s_add_u32 s28, s28, s29
    s_lshl_b32 s41, s21, 2
    s_add_u32 s41, s41, s23
    s_lshl_b32 s41, s41, 1
    s_add_u32 s41, s41, s29
    s_lshl_b32 s37, s23, 8
    s_add_u32 s37, s37, 10092544
    v_lshrrev_b32 v2, 3, v0
    v_lshlrev_b32 v2, 5, v2
    v_and_b32 v140, 7, v0
    v_add_u32 v2, v2, v140
    v_lshlrev_b32 v167, 5, v2
    s_lshl_b32 s41, s41, 11
    s_add_u32 s41, s41, 8388608
    s_lshl_b32 s40, s28, 10
    s_xor_b32 s30, s40, 1024
    s_add_u32 s40, s40, 90112
    s_add_u32 s30, s30, 90112
    v_lshlrev_b32 v1, 4, v0
    s_lshl_b32 s51, s44, 3
    s_add_u32 s51, s51, s45
    s_lshl_b32 s51, s51, 5
    s_add_u32 s51, s51, 10092544
    v_mov_b32 v165, 156160
    v_bfe_u32 v140, v0, 2, 3
    v_min_u32 v166, 6, v140
    s_mul_i32 s35, s23, 56
    s_add_u32 s35, s35, s45
    v_lshl_add_u32 v166, v166, 3, s35
    v_mul_u32_u24 v141, 2341, v166
    v_lshrrev_b32 v141, 16, v141
    v_lshl_add_u32 v166, v141, 2, v166
    s_lshl_b32 s35, s44, 3
    v_cmp_gt_u32 vcc, 32, v0
    v_add_u32 v140, s35, v140
    s_mov_b32 s52, 10092552
    v_cndmask_b32 v166, v140, v166, vcc
    v_lshlrev_b32 v166, 5, v166
    s_lshl_b32 s35, s44, 1
    s_add_u32 s35, s35, s31
    s_lshl_b32 s34, s35, 7
    s_add_u32 s34, s34, 8650752
    v_and_b32 v8, 31, v0
    v_lshlrev_b32 v8, 2, v8
    s_lshl_b32 s49, s35, 3
    s_add_u32 s49, s49, s45
    s_lshl_b32 s49, s49, 2
    s_lshr_b32 s35, s20, 1
    s_add_u32 s49, s49, s35
    s_lshl_b32 s49, s49, 10
    s_add_u32 s49, s49, 4194304
    s_mul_i32 s35, s29, 146048
    s_add_u32 s35, s35, 10240
    v_add_u32 v158, s35, v1
    v_lshrrev_b32 v141, 5, v0
    v_and_b32 v140, 15, v0
    v_lshlrev_b32 v140, 4, v140
    v_lshl_add_u32 v140, v141, 8, v140
    v_add_u32 v3, s40, v140
    v_add_u32 v4, s30, v140
    v_add_u32 v6, s30, v1
    v_lshl_add_u32 v7, v0, 2, s30
    s_lshl_b32 s35, s20, 2
    s_add_u32 s36, s35, 156192
    s_xor_b32 s35, s35, 16
    s_add_u32 s35, s35, 156192
    v_mov_b32 v9, s36
    v_mov_b32 v10, s35
    v_mov_b32 v11, 1
    v_mov_b32 v5, 0xdddddddd
    s_mov_b32 s42, 0xffff
    s_mov_b32 s43, 0xffff
    v_and_b32 v140, 27, v0
    v_cmp_eq_u32 vcc, 16, v140
    v_mov_b32 v141, 0x3f803f80
    v_mov_b32 v156, -1
    v_cndmask_b32 v124, 0, v141, vcc
    v_mov_b32 v125, v124
    v_mov_b32 v126, v124
    v_mov_b32 v127, v124
    v_mov_b32 v128, v124
    v_mov_b32 v129, v124
    v_mov_b32 v130, v124
    v_mov_b32 v131, v124
    v_mov_b32 v132, v124
    v_mov_b32 v133, v124
    v_mov_b32 v134, v124
    v_mov_b32 v135, v124
    v_mov_b32 v136, v124
    v_mov_b32 v137, v124
    v_mov_b32 v138, v124
    v_mov_b32 v139, v124
    v_mov_b32 v12, 0
    s_waitcnt vmcnt(12)
    s_mov_b64 exec, 1
    ds_add_u32 v165, v11 offset:64
    s_mov_b64 exec, -1
    s_add_u32 m0, s69, 24576
    s_add_u32 s72, s57, s73
    buffer_load_dwordx4 v148, s[64:67], s72 offen lds
    buffer_load_dwordx4 v149, s[64:67], s72 offen offset:1024 lds
    s_add_u32 m0, s70, 24576
    s_add_u32 s72, s58, s73
    buffer_load_dwordx4 v148, s[64:67], s72 offen lds
    buffer_load_dwordx4 v149, s[64:67], s72 offen offset:1024 lds
    s_add_u32 m0, s71, 24576
    s_add_u32 s72, s59, s73
    buffer_load_dwordx4 v148, s[64:67], s72 offen lds
    buffer_load_dwordx4 v149, s[64:67], s72 offen offset:1024 lds
    s_add_u32 s73, s73, 128
    s_and_b32 s73, s73, 1023
    v_mov_b32 v13, 0
    v_mov_b32 v14, 0
    v_mov_b32 v15, 0
    v_mov_b32 v16, 0
    v_mov_b32 v17, 0
    v_mov_b32 v18, 0
    v_mov_b32 v19, 0
    v_mov_b32 v20, 0
    v_mov_b32 v21, 0
    v_mov_b32 v22, 0
    v_mov_b32 v23, 0
    v_mov_b32 v24, 0
    v_mov_b32 v25, 0
    v_mov_b32 v26, 0
    v_mov_b32 v27, 0
    v_mov_b32 v28, 0
    v_mov_b32 v29, 0
    v_mov_b32 v30, 0
    v_mov_b32 v31, 0
    v_mov_b32 v32, 0
    s_waitcnt vmcnt(12)
    s_mov_b64 exec, 1
    ds_add_u32 v165, v11 offset:64
    s_mov_b64 exec, -1
    s_add_u32 m0, s69, 40960
    s_add_u32 s72, s57, s73
    buffer_load_dwordx4 v148, s[64:67], s72 offen lds
    buffer_load_dwordx4 v149, s[64:67], s72 offen offset:1024 lds
    s_add_u32 m0, s70, 40960
    s_add_u32 s72, s58, s73
    buffer_load_dwordx4 v148, s[64:67], s72 offen lds
    buffer_load_dwordx4 v149, s[64:67], s72 offen offset:1024 lds
    s_add_u32 m0, s71, 40960
    s_add_u32 s72, s59, s73
    buffer_load_dwordx4 v148, s[64:67], s72 offen lds
    buffer_load_dwordx4 v149, s[64:67], s72 offen offset:1024 lds
    s_add_u32 s73, s73, 128
    s_and_b32 s73, s73, 1023
    v_mov_b32 v33, 0
    v_mov_b32 v34, 0
    v_mov_b32 v35, 0
    v_mov_b32 v36, 0
    v_mov_b32 v37, 0
    v_mov_b32 v38, 0
    v_mov_b32 v39, 0
    v_mov_b32 v40, 0
    v_mov_b32 v41, 0
    v_mov_b32 v42, 0
    v_mov_b32 v43, 0
    v_mov_b32 v44, 0
    v_mov_b32 v45, 0
    v_mov_b32 v46, 0
    v_mov_b32 v47, 0
    v_mov_b32 v48, 0
    v_mov_b32 v49, 0
    v_mov_b32 v50, 0
    v_mov_b32 v51, 0
    v_mov_b32 v52, 0
    s_waitcnt vmcnt(12)
    s_mov_b64 exec, 1
    ds_add_u32 v165, v11 offset:64
    s_mov_b64 exec, -1
    s_add_u32 m0, s69, 49152
    s_add_u32 s72, s57, s73
    buffer_load_dwordx4 v148, s[64:67], s72 offen lds
    buffer_load_dwordx4 v149, s[64:67], s72 offen offset:1024 lds
    s_add_u32 m0, s70, 49152
    s_add_u32 s72, s58, s73
    buffer_load_dwordx4 v148, s[64:67], s72 offen lds
    buffer_load_dwordx4 v149, s[64:67], s72 offen offset:1024 lds
    s_add_u32 m0, s71, 49152
    s_add_u32 s72, s59, s73
    buffer_load_dwordx4 v148, s[64:67], s72 offen lds
    buffer_load_dwordx4 v149, s[64:67], s72 offen offset:1024 lds
    s_add_u32 s73, s73, 128
    s_and_b32 s73, s73, 1023
    v_mov_b32 v53, 0
    v_mov_b32 v54, 0
    v_mov_b32 v55, 0
    v_mov_b32 v56, 0
    v_mov_b32 v57, 0
    v_mov_b32 v58, 0
    v_mov_b32 v59, 0
    v_mov_b32 v60, 0
    v_mov_b32 v61, 0
    v_mov_b32 v62, 0
    v_mov_b32 v63, 0
    v_mov_b32 v64, 0
    v_mov_b32 v65, 0
    v_mov_b32 v66, 0
    v_mov_b32 v67, 0
    v_mov_b32 v68, 0
    v_mov_b32 v69, 0
    v_mov_b32 v70, 0
    v_mov_b32 v71, 0
    v_mov_b32 v72, 0
    s_waitcnt vmcnt(12)
    s_mov_b64 exec, 1
    ds_add_u32 v165, v11 offset:64
    s_mov_b64 exec, -1
    s_add_u32 m0, s69, 32768
    s_add_u32 s72, s57, s73
    buffer_load_dwordx4 v148, s[64:67], s72 offen lds
    buffer_load_dwordx4 v149, s[64:67], s72 offen offset:1024 lds
    s_add_u32 m0, s70, 32768
    s_add_u32 s72, s58, s73
    buffer_load_dwordx4 v148, s[64:67], s72 offen lds
    buffer_load_dwordx4 v149, s[64:67], s72 offen offset:1024 lds
    s_add_u32 m0, s71, 32768
    s_add_u32 s72, s59, s73
    buffer_load_dwordx4 v148, s[64:67], s72 offen lds
    buffer_load_dwordx4 v149, s[64:67], s72 offen offset:1024 lds
    s_add_u32 s73, s73, 128
    s_and_b32 s73, s73, 1023
    v_mov_b32 v73, 0
    v_mov_b32 v74, 0
    v_mov_b32 v75, 0
    s_sub_u32 s36, s23, 1
    s_and_b32 s36, s36, 3
    s_sub_u32 s36, s36, s23
    s_lshl_b32 s36, s36, 11
    v_add_u32 v159, s36, v6
    v_add_u32 v160, s36, v7
    s_sub_u32 s36, s23, 2
    s_and_b32 s36, s36, 3
    s_sub_u32 s36, s36, s23
    s_lshl_b32 s36, s36, 11
    v_add_u32 v161, s36, v6
    v_add_u32 v162, s36, v7
    s_sub_u32 s36, s23, 3
    s_and_b32 s36, s36, 3
    s_sub_u32 s36, s36, s23
    s_lshl_b32 s36, s36, 11
    v_add_u32 v163, s36, v6
    s_waitcnt vmcnt(12)
    s_mov_b64 exec, 1
    ds_add_u32 v165, v11 offset:64
    s_mov_b64 exec, -1
    s_add_u32 m0, s69, 57344
    s_add_u32 s72, s57, s73
    buffer_load_dwordx4 v148, s[64:67], s72 offen lds
    buffer_load_dwordx4 v149, s[64:67], s72 offen offset:1024 lds
    s_add_u32 m0, s70, 57344
    s_add_u32 s72, s58, s73
    buffer_load_dwordx4 v148, s[64:67], s72 offen lds
    buffer_load_dwordx4 v149, s[64:67], s72 offen offset:1024 lds
    s_add_u32 m0, s71, 57344
    s_add_u32 s72, s59, s73
    buffer_load_dwordx4 v148, s[64:67], s72 offen lds
    buffer_load_dwordx4 v149, s[64:67], s72 offen offset:1024 lds
    s_add_u32 s73, s73, 128
    s_and_b32 s73, s73, 1023
    v_add_u32 v164, s36, v7
    s_and_b32 s35, s20, 4
    s_add_u32 s35, s35, 156168
    v_mov_b32 v157, s35
    s_mov_b32 s53, 0x2b800000
    s_mov_b32 s54, 0x28000000
    s_add_u32 s28, s23, 1
    s_and_b32 s28, s28, 3
    s_lshl_b32 s28, s28, 10
    s_add_u32 s29, s23, 2
    s_and_b32 s29, s29, 3
    s_lshl_b32 s29, s29, 10
    s_add_u32 s30, s23, 3
    s_and_b32 s30, s30, 3
    s_lshl_b32 s30, s30, 10
    s_add_u32 s31, s23, 4
    s_and_b32 s31, s31, 3
    s_lshl_b32 s31, s31, 10
    s_waitcnt vmcnt(12)
    s_mov_b64 exec, 1
    ds_add_u32 v165, v11 offset:64
    s_mov_b64 exec, -1
    s_waitcnt vmcnt(6)
    s_mov_b64 exec, 1
    ds_add_u32 v165, v11 offset:64
    s_mov_b64 exec, -1
    s_waitcnt vmcnt(0)
    s_mov_b64 exec, 1
    ds_add_u32 v165, v11 offset:64
    s_mov_b64 exec, -1
    s_branch K_idle
K_kv:
    s_setprio 3
    s_lshr_b32 s64, s45, 1
    s_lshl_b32 s65, s64, 11
    v_and_b32 v153, 15, v0
    v_lshrrev_b32 v154, 4, v0
    v_bfe_u32 v155, v0, 1, 3
    v_xor_b32 v155, v155, v154
    v_lshlrev_b32 v155, 4, v155
    v_lshl_add_u32 v148, v153, 7, v155
    v_add_u32 v148, s65, v148
    v_xor_b32 v149, 64, v148
    v_lshlrev_b32 v150, 8, v154
    v_lshl_add_u32 v150, v153, 3, v150
    v_add_u32 v150, 131072, v150
    s_lshl_b32 s66, s44, 1
    s_lshr_b32 s67, s45, 2
    s_add_u32 s66, s66, s67
    s_lshl_b32 s66, s66, 11
    s_add_u32 s66, s66, 8388608
    s_and_b32 s64, s64, 1
    v_and_b32 v155, 1, v154
    v_lshrrev_b32 v154, 1, v154
    v_lshlrev_b32 v151, 4, v153
    v_mov_b32 v165, 156160
    s_mov_b32 s42, 0xffff
    s_mov_b32 s43, 0xffff
    s_barrier
    s_waitcnt lgkmcnt(0)
    s_bitcmp1_b32 s45, 0
    s_cbranch_scc1 K_v
    v_lshl_add_u32 v151, v155, 9, v151
    s_lshl_b32 s64, s64, 8
    s_add_u32 s66, s66, s64
K_kl0:
    ds_read_b32 v84, v165 offset:76
    s_waitcnt lgkmcnt(0)
    v_readfirstlane_b32 s67, v84
    s_cmp_ge_u32 s67, 1
    s_cbranch_scc1 K_kl0_ok
    s_sleep 1
    s_branch K_kl0
K_kl0_ok:
    ds_read_b64_tr_b16 v[92:93], v150 offset:0
    ds_read_b64_tr_b16 v[94:95], v150 offset:128
    ds_read_b128 v[96:99], v148 offset:0
    ds_read_b64_tr_b16 v[100:101], v150 offset:1024
    ds_read_b64_tr_b16 v[102:103], v150 offset:1152
    ds_read_b128 v[104:107], v149 offset:0
    ds_read_b64_tr_b16 v[108:109], v150 offset:2048
    ds_read_b64_tr_b16 v[110:111], v150 offset:2176
    ds_read_b128 v[112:115], v148 offset:8192
    ds_read_b64_tr_b16 v[116:117], v150 offset:3072
    ds_read_b64_tr_b16 v[118:119], v150 offset:3200
    ds_read_b128 v[120:123], v149 offset:8192
    s_waitcnt lgkmcnt(9)
    v_mfma_f32_16x16x32_bf16 v[76:79], v[92:95], v[96:99], 0
    ds_read_b64_tr_b16 v[92:93], v150 offset:4096
    ds_read_b64_tr_b16 v[94:95], v150 offset:4224
    ds_read_b128 v[96:99], v148 offset:16384
    s_waitcnt lgkmcnt(9)
    v_mfma_f32_16x16x32_bf16 v[76:79], v[100:103], v[104:107], v[76:79]
    ds_read_b64_tr_b16 v[100:101], v150 offset:5120
    ds_read_b64_tr_b16 v[102:103], v150 offset:5248
    ds_read_b128 v[104:107], v149 offset:16384
    s_waitcnt lgkmcnt(9)
    v_mfma_f32_16x16x32_bf16 v[76:79], v[108:111], v[112:115], v[76:79]
    ds_read_b64_tr_b16 v[108:109], v150 offset:6144
    ds_read_b64_tr_b16 v[110:111], v150 offset:6272
    ds_read_b128 v[112:115], v148 offset:24576
    s_waitcnt lgkmcnt(9)
    v_mfma_f32_16x16x32_bf16 v[76:79], v[116:119], v[120:123], v[76:79]
    ds_read_b64_tr_b16 v[116:117], v150 offset:7168
    ds_read_b64_tr_b16 v[118:119], v150 offset:7296
    ds_read_b128 v[120:123], v149 offset:24576
    s_waitcnt lgkmcnt(9)
    v_mfma_f32_16x16x32_bf16 v[76:79], v[92:95], v[96:99], v[76:79]
    ds_read_b64_tr_b16 v[92:93], v150 offset:8192
    ds_read_b64_tr_b16 v[94:95], v150 offset:8320
    ds_read_b128 v[96:99], v148 offset:40960
    s_waitcnt lgkmcnt(9)
    v_mfma_f32_16x16x32_bf16 v[76:79], v[100:103], v[104:107], v[76:79]
    ds_read_b64_tr_b16 v[100:101], v150 offset:9216
    ds_read_b64_tr_b16 v[102:103], v150 offset:9344
    ds_read_b128 v[104:107], v149 offset:40960
    s_waitcnt lgkmcnt(9)
    v_mfma_f32_16x16x32_bf16 v[76:79], v[108:111], v[112:115], v[76:79]
    ds_read_b64_tr_b16 v[108:109], v150 offset:10240
    ds_read_b64_tr_b16 v[110:111], v150 offset:10368
    ds_read_b128 v[112:115], v148 offset:49152
    s_waitcnt lgkmcnt(9)
    v_mfma_f32_16x16x32_bf16 v[76:79], v[116:119], v[120:123], v[76:79]
    ds_read_b64_tr_b16 v[116:117], v150 offset:11264
    ds_read_b64_tr_b16 v[118:119], v150 offset:11392
    ds_read_b128 v[120:123], v149 offset:49152
    s_waitcnt lgkmcnt(9)
    v_mfma_f32_16x16x32_bf16 v[76:79], v[92:95], v[96:99], v[76:79]
    ds_read_b64_tr_b16 v[92:93], v150 offset:12288
    ds_read_b64_tr_b16 v[94:95], v150 offset:12416
    ds_read_b128 v[96:99], v148 offset:32768
    s_waitcnt lgkmcnt(9)
    v_mfma_f32_16x16x32_bf16 v[76:79], v[100:103], v[104:107], v[76:79]
    ds_read_b64_tr_b16 v[100:101], v150 offset:13312
    ds_read_b64_tr_b16 v[102:103], v150 offset:13440
    ds_read_b128 v[104:107], v149 offset:32768
    s_waitcnt lgkmcnt(9)
    v_mfma_f32_16x16x32_bf16 v[76:79], v[108:111], v[112:115], v[76:79]
    ds_read_b64_tr_b16 v[108:109], v150 offset:14336
    ds_read_b64_tr_b16 v[110:111], v150 offset:14464
    ds_read_b128 v[112:115], v148 offset:57344
    s_waitcnt lgkmcnt(9)
    v_mfma_f32_16x16x32_bf16 v[76:79], v[116:119], v[120:123], v[76:79]
    ds_read_b64_tr_b16 v[116:117], v150 offset:15360
    ds_read_b64_tr_b16 v[118:119], v150 offset:15488
    ds_read_b128 v[120:123], v149 offset:57344
    s_waitcnt lgkmcnt(9)
    v_mfma_f32_16x16x32_bf16 v[76:79], v[92:95], v[96:99], v[76:79]
    s_waitcnt lgkmcnt(6)
    v_mfma_f32_16x16x32_bf16 v[76:79], v[100:103], v[104:107], v[76:79]
    s_waitcnt lgkmcnt(3)
    v_mfma_f32_16x16x32_bf16 v[76:79], v[108:111], v[112:115], v[76:79]
    s_waitcnt lgkmcnt(0)
    v_mfma_f32_16x16x32_bf16 v[76:79], v[116:119], v[120:123], v[76:79]
    s_nop 7
    v_cvt_pk_bf16_f32 v80, v76, v77
    v_cvt_pk_bf16_f32 v81, v78, v79
    s_nop 1
    v_permlane32_swap_b32 v80, v82
    v_permlane32_swap_b32 v81, v83
    s_mov_b32 exec_hi, 0
    buffer_store_dwordx4 v[80:83], v151, s[8:11], s66 offen offset:0 sc1
    s_mov_b64 exec, -1
    s_branch K_kv2
K_v:
    v_lshl_add_u32 v151, v154, 8, v151
    s_lshl_b32 s64, s64, 9
    s_add_u32 s66, s66, s64
K_kl1:
    ds_read_b32 v84, v165 offset:76
    s_waitcnt lgkmcnt(0)
    v_readfirstlane_b32 s67, v84
    s_cmp_ge_u32 s67, 1
    s_cbranch_scc1 K_kl1_ok
    s_sleep 1
    s_branch K_kl1
K_kl1_ok:
    s_nop 0
    ds_read_b64_tr_b16 v[92:93], v150 offset:0
    ds_read_b64_tr_b16 v[94:95], v150 offset:128
    ds_read_b128 v[96:99], v148 offset:0
    ds_read_b64_tr_b16 v[100:101], v150 offset:1024
    ds_read_b64_tr_b16 v[102:103], v150 offset:1152
    ds_read_b128 v[104:107], v149 offset:0
    ds_read_b64_tr_b16 v[108:109], v150 offset:2048
    ds_read_b64_tr_b16 v[110:111], v150 offset:2176
    ds_read_b128 v[112:115], v148 offset:8192
    ds_read_b64_tr_b16 v[116:117], v150 offset:3072
    ds_read_b64_tr_b16 v[118:119], v150 offset:3200
    ds_read_b128 v[120:123], v149 offset:8192
    s_waitcnt lgkmcnt(9)
    v_mfma_f32_16x16x32_bf16 v[76:79], v[96:99], v[92:95], 0
    ds_read_b64_tr_b16 v[92:93], v150 offset:4096
    ds_read_b64_tr_b16 v[94:95], v150 offset:4224
    ds_read_b128 v[96:99], v148 offset:16384
    s_waitcnt lgkmcnt(9)
    v_mfma_f32_16x16x32_bf16 v[76:79], v[104:107], v[100:103], v[76:79]
    ds_read_b64_tr_b16 v[100:101], v150 offset:5120
    ds_read_b64_tr_b16 v[102:103], v150 offset:5248
    ds_read_b128 v[104:107], v149 offset:16384
    s_waitcnt lgkmcnt(9)
    v_mfma_f32_16x16x32_bf16 v[76:79], v[112:115], v[108:111], v[76:79]
    ds_read_b64_tr_b16 v[108:109], v150 offset:6144
    ds_read_b64_tr_b16 v[110:111], v150 offset:6272
    ds_read_b128 v[112:115], v148 offset:24576
    s_waitcnt lgkmcnt(9)
    v_mfma_f32_16x16x32_bf16 v[76:79], v[120:123], v[116:119], v[76:79]
    ds_read_b64_tr_b16 v[116:117], v150 offset:7168
    ds_read_b64_tr_b16 v[118:119], v150 offset:7296
    ds_read_b128 v[120:123], v149 offset:24576
    s_waitcnt lgkmcnt(9)
    v_mfma_f32_16x16x32_bf16 v[76:79], v[96:99], v[92:95], v[76:79]
    ds_read_b64_tr_b16 v[92:93], v150 offset:8192
    ds_read_b64_tr_b16 v[94:95], v150 offset:8320
    ds_read_b128 v[96:99], v148 offset:40960
    s_waitcnt lgkmcnt(9)
    v_mfma_f32_16x16x32_bf16 v[76:79], v[104:107], v[100:103], v[76:79]
    ds_read_b64_tr_b16 v[100:101], v150 offset:9216
    ds_read_b64_tr_b16 v[102:103], v150 offset:9344
    ds_read_b128 v[104:107], v149 offset:40960
    s_waitcnt lgkmcnt(9)
    v_mfma_f32_16x16x32_bf16 v[76:79], v[112:115], v[108:111], v[76:79]
    ds_read_b64_tr_b16 v[108:109], v150 offset:10240
    ds_read_b64_tr_b16 v[110:111], v150 offset:10368
    ds_read_b128 v[112:115], v148 offset:49152
    s_waitcnt lgkmcnt(9)
    v_mfma_f32_16x16x32_bf16 v[76:79], v[120:123], v[116:119], v[76:79]
    ds_read_b64_tr_b16 v[116:117], v150 offset:11264
    ds_read_b64_tr_b16 v[118:119], v150 offset:11392
    ds_read_b128 v[120:123], v149 offset:49152
    s_waitcnt lgkmcnt(9)
    v_mfma_f32_16x16x32_bf16 v[76:79], v[96:99], v[92:95], v[76:79]
    ds_read_b64_tr_b16 v[92:93], v150 offset:12288
    ds_read_b64_tr_b16 v[94:95], v150 offset:12416
    ds_read_b128 v[96:99], v148 offset:32768
    s_waitcnt lgkmcnt(9)
    v_mfma_f32_16x16x32_bf16 v[76:79], v[104:107], v[100:103], v[76:79]
    ds_read_b64_tr_b16 v[100:101], v150 offset:13312
    ds_read_b64_tr_b16 v[102:103], v150 offset:13440
    ds_read_b128 v[104:107], v149 offset:32768
    s_waitcnt lgkmcnt(9)
    v_mfma_f32_16x16x32_bf16 v[76:79], v[112:115], v[108:111], v[76:79]
    ds_read_b64_tr_b16 v[108:109], v150 offset:14336
    ds_read_b64_tr_b16 v[110:111], v150 offset:14464
    ds_read_b128 v[112:115], v148 offset:57344
    s_waitcnt lgkmcnt(9)
    v_mfma_f32_16x16x32_bf16 v[76:79], v[120:123], v[116:119], v[76:79]
    ds_read_b64_tr_b16 v[116:117], v150 offset:15360
    ds_read_b64_tr_b16 v[118:119], v150 offset:15488
    ds_read_b128 v[120:123], v149 offset:57344
    s_waitcnt lgkmcnt(9)
    v_mfma_f32_16x16x32_bf16 v[76:79], v[96:99], v[92:95], v[76:79]
    s_waitcnt lgkmcnt(6)
    v_mfma_f32_16x16x32_bf16 v[76:79], v[104:107], v[100:103], v[76:79]
    s_waitcnt lgkmcnt(3)
    v_mfma_f32_16x16x32_bf16 v[76:79], v[112:115], v[108:111], v[76:79]
    s_waitcnt lgkmcnt(0)
    v_mfma_f32_16x16x32_bf16 v[76:79], v[120:123], v[116:119], v[76:79]
    s_nop 7
    v_cvt_pk_bf16_f32 v80, v76, v77
    v_cvt_pk_bf16_f32 v81, v78, v79
    s_nop 1
    v_permlane16_swap_b32 v80, v82
    v_permlane16_swap_b32 v81, v83
    s_mov_b64 exec, s[42:43]
    buffer_store_dwordx4 v[80:83], v151, s[8:11], s66 offen offset:1024 sc1
    s_mov_b64 exec, -1
K_kv2:
    s_branch K_cleared
K_kv3:
    s_waitcnt vmcnt(0)
    s_mov_b64 exec, 1
    ds_add_rtn_u32 v2, v165, v11 offset:24
    s_waitcnt lgkmcnt(0)
    v_readfirstlane_b32 s35, v2
    s_cmp_lg_u32 s35, 4
    s_cbranch_scc1 K_kvf
    buffer_store_dword v11, v1, s[8:11], s51 offen offset:0 sc1
K_kvf:
    s_mov_b64 exec, -1
    s_branch K_idle
K_q:
    s_setprio 0
    s_sub_u32 s64, s20, 2
    s_and_b32 s65, s64, 1
    s_lshr_b32 s64, s64, 1
    s_lshl_b32 s66, s65, 12
    v_and_b32 v153, 31, v0
    v_lshrrev_b32 v154, 5, v0
    v_bfe_u32 v155, v0, 1, 3
    v_xor_b32 v155, v155, v154
    v_lshlrev_b32 v155, 4, v155
    v_lshl_add_u32 v148, v153, 7, v155
    v_add_u32 v148, s66, v148
    v_xor_b32 v149, 32, v148
    v_xor_b32 v150, 64, v148
    v_xor_b32 v151, 96, v148
    s_mov_b32 s67, 65536
    v_lshrrev_b32 v154, 5, v0
    v_lshlrev_b32 v152, 3, v154
    v_bfe_u32 v154, v0, 2, 2
    v_add_u32 v152, v152, v154
    v_lshlrev_b32 v152, 7, v152
    v_bfe_u32 v154, v0, 4, 1
    v_lshl_add_u32 v152, v154, 5, v152
    v_and_b32 v154, 3, v0
    v_lshl_add_u32 v152, v154, 3, v152
    v_bfe_u32 v154, v0, 3, 1
    v_lshl_add_u32 v152, v154, 6, v152
    v_add_u32 v152, s67, v152
    v_xor_b32 v153, 64, v152
    s_lshl_b32 s66, s64, 6
    v_xor_b32 v152, s66, v152
    s_mul_i32 s66, s64, 146048
    s_lshl_b32 s67, s65, 10
    s_add_u32 s66, s66, s67
    s_add_u32 s66, s66, 10240
    v_add_u32 v153, s66, v1
    s_mov_b32 s68, 0x3eb8aa3b
    s_mov_b32 s69, s68
    s_mov_b32 s70, 0
K_qs:
    ds_read_b32 v154, v165 offset:76
    s_waitcnt lgkmcnt(0)
    v_readfirstlane_b32 s71, v154
    s_cmp_ge_u32 s71, 1
    s_cbranch_scc1 K_qs_ok
    s_sleep 1
    s_branch K_qs
K_qs_ok:
    s_cmp_ge_u32 s70, 1
    s_cbranch_scc1 K_ql0_ok
K_ql0:
    ds_read_b64 v[154:155], v165 offset:64
    s_waitcnt lgkmcnt(0)
    v_min_u32 v154, v154, v155
    s_nop 0
    v_readfirstlane_b32 s70, v154
    s_cmp_ge_u32 s70, 1
    s_cbranch_scc1 K_ql0_ok
    s_sleep 1
    s_branch K_ql0
K_ql0_ok:
    s_nop 0
    ds_read_b64_tr_b16 v[92:93], v152 offset:0
    ds_read_b64_tr_b16 v[94:95], v152 offset:512
    ds_read_b128 v[96:99], v148 offset:0
    ds_read_b64_tr_b16 v[100:101], v152 offset:2048
    ds_read_b64_tr_b16 v[102:103], v152 offset:2560
    ds_read_b128 v[104:107], v149 offset:0
    ds_read_b64_tr_b16 v[108:109], v152 offset:4096
    ds_read_b64_tr_b16 v[110:111], v152 offset:4608
    ds_read_b128 v[112:115], v150 offset:0
    ds_read_b64_tr_b16 v[116:117], v152 offset:6144
    ds_read_b64_tr_b16 v[118:119], v152 offset:6656
    ds_read_b128 v[120:123], v151 offset:0
    s_cmp_ge_u32 s70, 2
    s_cbranch_scc1 K_ql1_ok
K_ql1:
    ds_read_b64 v[154:155], v165 offset:64
    s_waitcnt lgkmcnt(0)
    v_min_u32 v154, v154, v155
    s_nop 0
    v_readfirstlane_b32 s70, v154
    s_cmp_ge_u32 s70, 2
    s_cbranch_scc1 K_ql1_ok
    s_sleep 1
    s_branch K_ql1
K_ql1_ok:
    s_waitcnt lgkmcnt(9)
    v_mfma_f32_32x32x16_bf16 v[76:91], v[92:95], v[96:99], 0
    ds_read_b64_tr_b16 v[92:93], v152 offset:8192
    ds_read_b64_tr_b16 v[94:95], v152 offset:8704
    ds_read_b128 v[96:99], v148 offset:8192
    ds_read_b64 v[154:155], v165 offset:64
    s_waitcnt lgkmcnt(10)
    v_mfma_f32_32x32x16_bf16 v[76:91], v[100:103], v[104:107], v[76:91]
    ds_read_b64_tr_b16 v[100:101], v152 offset:10240
    ds_read_b64_tr_b16 v[102:103], v152 offset:10752
    ds_read_b128 v[104:107], v149 offset:8192
    s_waitcnt lgkmcnt(10)
    v_mfma_f32_32x32x16_bf16 v[76:91], v[108:111], v[112:115], v[76:91]
    ds_read_b64_tr_b16 v[108:109], v152 offset:12288
    ds_read_b64_tr_b16 v[110:111], v152 offset:12800
    ds_read_b128 v[112:115], v150 offset:8192
    s_waitcnt lgkmcnt(10)
    v_mfma_f32_32x32x16_bf16 v[76:91], v[116:119], v[120:123], v[76:91]
    ds_read_b64_tr_b16 v[116:117], v152 offset:14336
    ds_read_b64_tr_b16 v[118:119], v152 offset:14848
    ds_read_b128 v[120:123], v151 offset:8192
    s_waitcnt lgkmcnt(9)
    v_min_u32 v154, v154, v155
    s_nop 0
    v_readfirstlane_b32 s70, v154
    s_cmp_ge_u32 s70, 3
    s_cbranch_scc1 K_ql2_ok
K_ql2:
    ds_read_b64 v[154:155], v165 offset:64
    s_waitcnt lgkmcnt(0)
    v_min_u32 v154, v154, v155
    s_nop 0
    v_readfirstlane_b32 s70, v154
    s_cmp_ge_u32 s70, 3
    s_cbranch_scc1 K_ql2_ok
    s_sleep 1
    s_branch K_ql2
K_ql2_ok:
    s_waitcnt lgkmcnt(9)
    v_mfma_f32_32x32x16_bf16 v[76:91], v[92:95], v[96:99], v[76:91]
    ds_read_b64_tr_b16 v[92:93], v152 offset:16384
    ds_read_b64_tr_b16 v[94:95], v152 offset:16896
    ds_read_b128 v[96:99], v148 offset:16384
    ds_read_b64 v[154:155], v165 offset:64
    s_waitcnt lgkmcnt(10)
    v_mfma_f32_32x32x16_bf16 v[76:91], v[100:103], v[104:107], v[76:91]
    ds_read_b64_tr_b16 v[100:101], v152 offset:18432
    ds_read_b64_tr_b16 v[102:103], v152 offset:18944
    ds_read_b128 v[104:107], v149 offset:16384
    s_waitcnt lgkmcnt(10)
    v_mfma_f32_32x32x16_bf16 v[76:91], v[108:111], v[112:115], v[76:91]
    ds_read_b64_tr_b16 v[108:109], v152 offset:20480
    ds_read_b64_tr_b16 v[110:111], v152 offset:20992
    ds_read_b128 v[112:115], v150 offset:16384
    s_waitcnt lgkmcnt(10)
    v_mfma_f32_32x32x16_bf16 v[76:91], v[116:119], v[120:123], v[76:91]
    ds_read_b64_tr_b16 v[116:117], v152 offset:22528
    ds_read_b64_tr_b16 v[118:119], v152 offset:23040
    ds_read_b128 v[120:123], v151 offset:16384
    s_waitcnt lgkmcnt(9)
    v_min_u32 v154, v154, v155
    s_nop 0
    v_readfirstlane_b32 s70, v154
    s_cmp_ge_u32 s70, 4
    s_cbranch_scc1 K_ql3_ok
K_ql3:
    ds_read_b64 v[154:155], v165 offset:64
    s_waitcnt lgkmcnt(0)
    v_min_u32 v154, v154, v155
    s_nop 0
    v_readfirstlane_b32 s70, v154
    s_cmp_ge_u32 s70, 4
    s_cbranch_scc1 K_ql3_ok
    s_sleep 1
    s_branch K_ql3
K_ql3_ok:
    s_waitcnt lgkmcnt(9)
    v_mfma_f32_32x32x16_bf16 v[76:91], v[92:95], v[96:99], v[76:91]
    ds_read_b64_tr_b16 v[92:93], v152 offset:24576
    ds_read_b64_tr_b16 v[94:95], v152 offset:25088
    ds_read_b128 v[96:99], v148 offset:24576
    ds_read_b64 v[154:155], v165 offset:64
    s_waitcnt lgkmcnt(10)
    v_mfma_f32_32x32x16_bf16 v[76:91], v[100:103], v[104:107], v[76:91]
    ds_read_b64_tr_b16 v[100:101], v152 offset:26624
    ds_read_b64_tr_b16 v[102:103], v152 offset:27136
    ds_read_b128 v[104:107], v149 offset:24576
    s_waitcnt lgkmcnt(10)
    v_mfma_f32_32x32x16_bf16 v[76:91], v[108:111], v[112:115], v[76:91]
    ds_read_b64_tr_b16 v[108:109], v152 offset:28672
    ds_read_b64_tr_b16 v[110:111], v152 offset:29184
    ds_read_b128 v[112:115], v150 offset:24576
    s_waitcnt lgkmcnt(10)
    v_mfma_f32_32x32x16_bf16 v[76:91], v[116:119], v[120:123], v[76:91]
    ds_read_b64_tr_b16 v[116:117], v152 offset:30720
    ds_read_b64_tr_b16 v[118:119], v152 offset:31232
    ds_read_b128 v[120:123], v151 offset:24576
    s_waitcnt lgkmcnt(9)
    v_min_u32 v154, v154, v155
    s_nop 0
    v_readfirstlane_b32 s70, v154
    s_cmp_ge_u32 s70, 5
    s_cbranch_scc1 K_ql4_ok
K_ql4:
    ds_read_b64 v[154:155], v165 offset:64
    s_waitcnt lgkmcnt(0)
    v_min_u32 v154, v154, v155
    s_nop 0
    v_readfirstlane_b32 s70, v154
    s_cmp_ge_u32 s70, 5
    s_cbranch_scc1 K_ql4_ok
    s_sleep 1
    s_branch K_ql4
K_ql4_ok:
    s_waitcnt lgkmcnt(9)
    v_mfma_f32_32x32x16_bf16 v[76:91], v[92:95], v[96:99], v[76:91]
    ds_read_b64_tr_b16 v[92:93], v152 offset:32768
    ds_read_b64_tr_b16 v[94:95], v152 offset:33280
    ds_read_b128 v[96:99], v148 offset:40960
    ds_read_b64 v[154:155], v165 offset:64
    s_waitcnt lgkmcnt(10)
    v_mfma_f32_32x32x16_bf16 v[76:91], v[100:103], v[104:107], v[76:91]
    ds_read_b64_tr_b16 v[100:101], v152 offset:34816
    ds_read_b64_tr_b16 v[102:103], v152 offset:35328
    ds_read_b128 v[104:107], v149 offset:40960
    s_waitcnt lgkmcnt(10)
    v_mfma_f32_32x32x16_bf16 v[76:91], v[108:111], v[112:115], v[76:91]
    ds_read_b64_tr_b16 v[108:109], v152 offset:36864
    ds_read_b64_tr_b16 v[110:111], v152 offset:37376
    ds_read_b128 v[112:115], v150 offset:40960
    s_waitcnt lgkmcnt(10)
    v_mfma_f32_32x32x16_bf16 v[76:91], v[116:119], v[120:123], v[76:91]
    ds_read_b64_tr_b16 v[116:117], v152 offset:38912
    ds_read_b64_tr_b16 v[118:119], v152 offset:39424
    ds_read_b128 v[120:123], v151 offset:40960
    s_waitcnt lgkmcnt(9)
    v_min_u32 v154, v154, v155
    s_nop 0
    v_readfirstlane_b32 s70, v154
    s_cmp_ge_u32 s70, 6
    s_cbranch_scc1 K_ql5_ok
K_ql5:
    ds_read_b64 v[154:155], v165 offset:64
    s_waitcnt lgkmcnt(0)
    v_min_u32 v154, v154, v155
    s_nop 0
    v_readfirstlane_b32 s70, v154
    s_cmp_ge_u32 s70, 6
    s_cbranch_scc1 K_ql5_ok
    s_sleep 1
    s_branch K_ql5
K_ql5_ok:
    s_waitcnt lgkmcnt(9)
    v_mfma_f32_32x32x16_bf16 v[76:91], v[92:95], v[96:99], v[76:91]
    ds_read_b64_tr_b16 v[92:93], v152 offset:40960
    ds_read_b64_tr_b16 v[94:95], v152 offset:41472
    ds_read_b128 v[96:99], v148 offset:49152
    ds_read_b64 v[154:155], v165 offset:64
    s_waitcnt lgkmcnt(10)
    v_mfma_f32_32x32x16_bf16 v[76:91], v[100:103], v[104:107], v[76:91]
    ds_read_b64_tr_b16 v[100:101], v152 offset:43008
    ds_read_b64_tr_b16 v[102:103], v152 offset:43520
    ds_read_b128 v[104:107], v149 offset:49152
    s_waitcnt lgkmcnt(10)
    v_mfma_f32_32x32x16_bf16 v[76:91], v[108:111], v[112:115], v[76:91]
    ds_read_b64_tr_b16 v[108:109], v152 offset:45056
    ds_read_b64_tr_b16 v[110:111], v152 offset:45568
    ds_read_b128 v[112:115], v150 offset:49152
    s_waitcnt lgkmcnt(10)
    v_mfma_f32_32x32x16_bf16 v[76:91], v[116:119], v[120:123], v[76:91]
    ds_read_b64_tr_b16 v[116:117], v152 offset:47104
    ds_read_b64_tr_b16 v[118:119], v152 offset:47616
    ds_read_b128 v[120:123], v151 offset:49152
    s_waitcnt lgkmcnt(9)
    v_min_u32 v154, v154, v155
    s_nop 0
    v_readfirstlane_b32 s70, v154
    s_cmp_ge_u32 s70, 7
    s_cbranch_scc1 K_ql6_ok
K_ql6:
    ds_read_b64 v[154:155], v165 offset:64
    s_waitcnt lgkmcnt(0)
    v_min_u32 v154, v154, v155
    s_nop 0
    v_readfirstlane_b32 s70, v154
    s_cmp_ge_u32 s70, 7
    s_cbranch_scc1 K_ql6_ok
    s_sleep 1
    s_branch K_ql6
K_ql6_ok:
    s_waitcnt lgkmcnt(9)
    v_mfma_f32_32x32x16_bf16 v[76:91], v[92:95], v[96:99], v[76:91]
    ds_read_b64_tr_b16 v[92:93], v152 offset:49152
    ds_read_b64_tr_b16 v[94:95], v152 offset:49664
    ds_read_b128 v[96:99], v148 offset:32768
    ds_read_b64 v[154:155], v165 offset:64
    s_waitcnt lgkmcnt(10)
    v_mfma_f32_32x32x16_bf16 v[76:91], v[100:103], v[104:107], v[76:91]
    ds_read_b64_tr_b16 v[100:101], v152 offset:51200
    ds_read_b64_tr_b16 v[102:103], v152 offset:51712
    ds_read_b128 v[104:107], v149 offset:32768
    s_waitcnt lgkmcnt(10)
    v_mfma_f32_32x32x16_bf16 v[76:91], v[108:111], v[112:115], v[76:91]
    ds_read_b64_tr_b16 v[108:109], v152 offset:53248
    ds_read_b64_tr_b16 v[110:111], v152 offset:53760
    ds_read_b128 v[112:115], v150 offset:32768
    s_waitcnt lgkmcnt(10)
    v_mfma_f32_32x32x16_bf16 v[76:91], v[116:119], v[120:123], v[76:91]
    ds_read_b64_tr_b16 v[116:117], v152 offset:55296
    ds_read_b64_tr_b16 v[118:119], v152 offset:55808
    ds_read_b128 v[120:123], v151 offset:32768
    s_waitcnt lgkmcnt(9)
    v_min_u32 v154, v154, v155
    s_nop 0
    v_readfirstlane_b32 s70, v154
    s_cmp_ge_u32 s70, 8
    s_cbranch_scc1 K_ql7_ok
K_ql7:
    ds_read_b64 v[154:155], v165 offset:64
    s_waitcnt lgkmcnt(0)
    v_min_u32 v154, v154, v155
    s_nop 0
    v_readfirstlane_b32 s70, v154
    s_cmp_ge_u32 s70, 8
    s_cbranch_scc1 K_ql7_ok
    s_sleep 1
    s_branch K_ql7
K_ql7_ok:
    s_waitcnt lgkmcnt(9)
    v_mfma_f32_32x32x16_bf16 v[76:91], v[92:95], v[96:99], v[76:91]
    ds_read_b64_tr_b16 v[92:93], v152 offset:57344
    ds_read_b64_tr_b16 v[94:95], v152 offset:57856
    ds_read_b128 v[96:99], v148 offset:57344
    s_waitcnt lgkmcnt(9)
    v_mfma_f32_32x32x16_bf16 v[76:91], v[100:103], v[104:107], v[76:91]
    ds_read_b64_tr_b16 v[100:101], v152 offset:59392
    ds_read_b64_tr_b16 v[102:103], v152 offset:59904
    ds_read_b128 v[104:107], v149 offset:57344
    s_waitcnt lgkmcnt(9)
    v_mfma_f32_32x32x16_bf16 v[76:91], v[108:111], v[112:115], v[76:91]
    ds_read_b64_tr_b16 v[108:109], v152 offset:61440
    ds_read_b64_tr_b16 v[110:111], v152 offset:61952
    ds_read_b128 v[112:115], v150 offset:57344
    s_waitcnt lgkmcnt(9)
    v_mfma_f32_32x32x16_bf16 v[76:91], v[116:119], v[120:123], v[76:91]
    ds_read_b64_tr_b16 v[116:117], v152 offset:63488
    ds_read_b64_tr_b16 v[118:119], v152 offset:64000
    ds_read_b128 v[120:123], v151 offset:57344
    s_waitcnt lgkmcnt(9)
    v_mfma_f32_32x32x16_bf16 v[76:91], v[92:95], v[96:99], v[76:91]
    s_waitcnt lgkmcnt(6)
    v_mfma_f32_32x32x16_bf16 v[76:91], v[100:103], v[104:107], v[76:91]
    s_waitcnt lgkmcnt(3)
    v_mfma_f32_32x32x16_bf16 v[76:91], v[108:111], v[112:115], v[76:91]
    s_waitcnt lgkmcnt(0)
    v_mfma_f32_32x32x16_bf16 v[76:91], v[116:119], v[120:123], v[76:91]
    s_barrier
    s_setprio 3
    s_xor_b32 s25, s41, 0
    buffer_load_dwordx4 v[140:143], v1, s[8:11], s25 offen sc1
    s_add_u32 m0, s40, 40960
    s_xor_b32 s27, s41, 1024
    buffer_load_dwordx4 v1, s[8:11], s27 offen sc1 lds
    s_xor_b32 s25, s41, 2048
    buffer_load_dwordx4 v[144:147], v1, s[8:11], s25 offen sc1
    s_nop 2
    v_pk_mul_f32 v[76:77], v[76:77], s[68:69]
    v_pk_mul_f32 v[78:79], v[78:79], s[68:69]
    v_pk_mul_f32 v[80:81], v[80:81], s[68:69]
    v_pk_mul_f32 v[82:83], v[82:83], s[68:69]
    v_cvt_pk_bf16_f32 v92, v76, v77
    v_cvt_pk_bf16_f32 v93, v78, v79
    v_cvt_pk_bf16_f32 v94, v80, v81
    v_cvt_pk_bf16_f32 v95, v82, v83
    ds_write_b128 v153, v[92:95] offset:0
    v_pk_mul_f32 v[84:85], v[84:85], s[68:69]
    v_pk_mul_f32 v[86:87], v[86:87], s[68:69]
    v_pk_mul_f32 v[88:89], v[88:89], s[68:69]
    v_pk_mul_f32 v[90:91], v[90:91], s[68:69]
    v_cvt_pk_bf16_f32 v96, v84, v85
    v_cvt_pk_bf16_f32 v97, v86, v87
    v_cvt_pk_bf16_f32 v98, v88, v89
    v_cvt_pk_bf16_f32 v99, v90, v91
    ds_write_b128 v153, v[96:99] offset:2048
K_att:
    v_add_u32 v148, s28, v158
    v_add_u32 v149, s29, v158
    v_add_u32 v150, s30, v158
    v_add_u32 v151, s31, v158
    s_cmp_ge_u32 s20, 4
    s_cbranch_scc1 K_p8a
    buffer_load_dword v75, v167, s[8:11], s37 offen sc1
K_p8a:
    s_waitcnt lgkmcnt(0)
    s_barrier
    ds_read_b128 v[76:79], v148
    ds_read_b128 v[80:83], v149
    ds_read_b128 v[84:87], v150
    ds_read_b128 v[88:91], v151
    s_waitcnt vmcnt(1)
    s_mov_b64 exec, s[42:43]
    ds_read_b128 v[124:127], v3 offset:40960
    ds_read_b128 v[128:131], v3 offset:41472
    s_mov_b64 exec, -1
    s_mov_b64 exec, 1
    ds_add_u32 v9, v11
    s_mov_b64 exec, -1
    s_waitcnt lgkmcnt(3)
    v_mfma_f32_32x32x16_bf16 v[92:107], v[140:143], v[76:79], 0
    s_nop 7
    s_nop 2
    s_waitcnt lgkmcnt(0)
    v_exp_f32 v92, v92
    v_exp_f32 v93, v93
    v_exp_f32 v94, v94
    v_exp_f32 v95, v95
    v_mfma_f32_32x32x16_bf16 v[108:123], v[140:143], v[80:83], 0
    v_exp_f32 v96, v96
    v_exp_f32 v97, v97
    v_exp_f32 v98, v98
    v_exp_f32 v99, v99
    v_exp_f32 v100, v100
    v_exp_f32 v101, v101
    v_exp_f32 v102, v102
    v_exp_f32 v103, v103
    v_exp_f32 v104, v104
    v_exp_f32 v105, v105
    v_exp_f32 v106, v106
    v_exp_f32 v107, v107
    v_smfmac_f32_32x32x32_bf16 v[12:27], v[124:127], v[92:99], v5
    v_exp_f32 v108, v108
    v_exp_f32 v109, v109
    v_smfmac_f32_32x32x32_bf16 v[12:27], v[128:131], v[100:107], v5
    v_exp_f32 v110, v110
    v_exp_f32 v111, v111
    v_mfma_f32_32x32x16_bf16 v[92:107], v[140:143], v[84:87], 0
    v_exp_f32 v112, v112
    v_exp_f32 v113, v113
    v_exp_f32 v114, v114
    v_exp_f32 v115, v115
    v_exp_f32 v116, v116
    v_exp_f32 v117, v117
    v_exp_f32 v118, v118
    v_exp_f32 v119, v119
    v_exp_f32 v120, v120
    v_exp_f32 v121, v121
    v_exp_f32 v122, v122
    v_exp_f32 v123, v123
    v_smfmac_f32_32x32x32_bf16 v[28:43], v[124:127], v[108:115], v5
    v_exp_f32 v92, v92
    v_exp_f32 v93, v93
    v_smfmac_f32_32x32x32_bf16 v[28:43], v[128:131], v[116:123], v5
    s_cmp_lt_u32 s20, 4
    s_cbranch_scc1 K_wide_t
K_s0:
    ds_read_b32 v2, v10 offset:0
    s_waitcnt lgkmcnt(0)
    v_readfirstlane_b32 s33, v2
    s_cmp_ge_u32 s33, 2
    s_cbranch_scc1 K_s0_ok
    s_sleep 1
    s_branch K_s0
K_s0_ok:
    s_branch K_wide_ok
K_wide:
    buffer_load_dword v75, v167, s[8:11], s37 offen sc1
K_wide_t:
    s_waitcnt vmcnt(0)
    v_cmp_eq_u32 vcc, 0, v75
    s_cbranch_vccz K_wide_ok
    s_cmp_eq_u32 s60, 0
    s_cbranch_scc1 K_wide_ok
    s_sub_u32 s60, s60, 1
    s_mov_b64 exec, vcc
    s_sleep 2
    s_branch K_wide
K_wide_ok:
    s_mov_b64 exec, -1
    s_mov_b64 exec, 1
    ds_add_u32 v9, v11
    s_mov_b64 exec, -1
    s_xor_b32 s25, s41, 16384
    buffer_load_dwordx4 v[148:151], v1, s[8:11], s25 offen sc1
    s_add_u32 m0, s40, 49152
    s_xor_b32 s27, s41, 17408
    buffer_load_dwordx4 v1, s[8:11], s27 offen sc1 lds
    v_exp_f32 v94, v94
    v_exp_f32 v95, v95
    v_mfma_f32_32x32x16_bf16 v[108:123], v[140:143], v[88:91], 0
    v_exp_f32 v96, v96
    v_exp_f32 v97, v97
    v_exp_f32 v98, v98
    v_exp_f32 v99, v99
    v_exp_f32 v100, v100
    v_exp_f32 v101, v101
    v_exp_f32 v102, v102
    v_exp_f32 v103, v103
    v_exp_f32 v104, v104
    v_exp_f32 v105, v105
    v_exp_f32 v106, v106
    v_exp_f32 v107, v107
    v_smfmac_f32_32x32x32_bf16 v[44:59], v[124:127], v[92:99], v5
    v_exp_f32 v108, v108
    v_exp_f32 v109, v109
    v_smfmac_f32_32x32x32_bf16 v[44:59], v[128:131], v[100:107], v5
    s_xor_b32 s25, s41, 32768
    buffer_load_dwordx4 v[152:155], v1, s[8:11], s25 offen sc1
    s_add_u32 m0, s40, 57344
    s_xor_b32 s27, s41, 33792
    buffer_load_dwordx4 v1, s[8:11], s27 offen sc1 lds
K_s3:
    ds_read_b32 v2, v10 offset:0
    s_waitcnt lgkmcnt(0)
    v_readfirstlane_b32 s33, v2
    s_cmp_ge_u32 s33, 1
    s_cbranch_scc1 K_s3_ok
    s_sleep 1
    s_branch K_s3
K_s3_ok:
    s_mov_b64 exec, s[42:43]
    ds_read_b128 v[132:135], v4 offset:40960
    ds_read_b128 v[136:139], v4 offset:41472
    s_mov_b64 exec, -1
    v_exp_f32 v110, v110
    v_exp_f32 v111, v111
    s_waitcnt vmcnt(4)
    v_mfma_f32_32x32x16_bf16 v[92:107], v[144:147], v[76:79], 0
    v_exp_f32 v112, v112
    v_exp_f32 v113, v113
    v_exp_f32 v114, v114
    v_exp_f32 v115, v115
    v_exp_f32 v116, v116
    v_exp_f32 v117, v117
    v_exp_f32 v118, v118
    v_exp_f32 v119, v119
    v_exp_f32 v120, v120
    v_exp_f32 v121, v121
    v_exp_f32 v122, v122
    v_exp_f32 v123, v123
    v_smfmac_f32_32x32x32_bf16 v[60:75], v[124:127], v[108:115], v5
    s_waitcnt lgkmcnt(0)
    v_exp_f32 v92, v92
    v_exp_f32 v93, v93
    v_smfmac_f32_32x32x32_bf16 v[60:75], v[128:131], v[116:123], v5
    s_xor_b32 s25, s41, 49152
    buffer_load_dwordx4 v[140:143], v1, s[8:11], s25 offen sc1
    s_add_u32 m0, s40, 0
    s_xor_b32 s27, s41, 50176
    buffer_load_dwordx4 v1, s[8:11], s27 offen sc1 lds
    v_exp_f32 v94, v94
    v_exp_f32 v95, v95
    v_mfma_f32_32x32x16_bf16 v[108:123], v[144:147], v[80:83], 0
    v_exp_f32 v96, v96
    v_exp_f32 v97, v97
    v_exp_f32 v98, v98
    v_exp_f32 v99, v99
    v_exp_f32 v100, v100
    v_exp_f32 v101, v101
    v_exp_f32 v102, v102
    v_exp_f32 v103, v103
    v_exp_f32 v104, v104
    v_exp_f32 v105, v105
    v_exp_f32 v106, v106
    v_exp_f32 v107, v107
    v_smfmac_f32_32x32x32_bf16 v[12:27], v[132:135], v[92:99], v5
    v_exp_f32 v108, v108
    v_exp_f32 v109, v109
    v_smfmac_f32_32x32x32_bf16 v[12:27], v[136:139], v[100:107], v5
    s_add_u32 m0, s40, 8192
    s_xor_b32 s27, s41, 66560
    buffer_load_dwordx4 v1, s[8:11], s27 offen sc1 lds
    s_waitcnt vmcnt(5)
    s_mov_b64 exec, s[42:43]
    ds_read_b128 v[124:127], v3 offset:49152
    ds_read_b128 v[128:131], v3 offset:49664
    s_mov_b64 exec, -1
    v_exp_f32 v110, v110
    v_exp_f32 v111, v111
    v_mfma_f32_32x32x16_bf16 v[92:107], v[144:147], v[84:87], 0
    v_exp_f32 v112, v112
    v_exp_f32 v113, v113
    v_exp_f32 v114, v114
    v_exp_f32 v115, v115
    v_exp_f32 v116, v116
    v_exp_f32 v117, v117
    v_exp_f32 v118, v118
    v_exp_f32 v119, v119
    v_exp_f32 v120, v120
    v_exp_f32 v121, v121
    v_exp_f32 v122, v122
    v_exp_f32 v123, v123
    v_smfmac_f32_32x32x32_bf16 v[28:43], v[132:135], v[108:115], v5
    v_exp_f32 v92, v92
    v_exp_f32 v93, v93
    v_smfmac_f32_32x32x32_bf16 v[28:43], v[136:139], v[116:123], v5
    s_add_u32 m0, s40, 16384
    s_xor_b32 s27, s41, 82944
    buffer_load_dwordx4 v1, s[8:11], s27 offen sc1 lds
    v_exp_f32 v94, v94
    v_exp_f32 v95, v95
    v_mfma_f32_32x32x16_bf16 v[108:123], v[144:147], v[88:91], 0
    v_exp_f32 v96, v96
    v_exp_f32 v97, v97
    v_exp_f32 v98, v98
    v_exp_f32 v99, v99
    v_exp_f32 v100, v100
    v_exp_f32 v101, v101
    v_exp_f32 v102, v102
    v_exp_f32 v103, v103
    v_exp_f32 v104, v104
    v_exp_f32 v105, v105
    v_exp_f32 v106, v106
    v_exp_f32 v107, v107
    v_smfmac_f32_32x32x32_bf16 v[44:59], v[132:135], v[92:99], v5
    v_exp_f32 v108, v108
    v_exp_f32 v109, v109
    v_smfmac_f32_32x32x32_bf16 v[44:59], v[136:139], v[100:107], v5
    v_exp_f32 v110, v110
    v_exp_f32 v111, v111
    v_mfma_f32_32x32x16_bf16 v[92:107], v[148:151], v[76:79], 0
    v_exp_f32 v112, v112
    v_exp_f32 v113, v113
    v_exp_f32 v114, v114
    v_exp_f32 v115, v115
    v_exp_f32 v116, v116
    v_exp_f32 v117, v117
    v_exp_f32 v118, v118
    v_exp_f32 v119, v119
    v_exp_f32 v120, v120
    v_exp_f32 v121, v121
    v_exp_f32 v122, v122
    v_exp_f32 v123, v123
    v_smfmac_f32_32x32x32_bf16 v[60:75], v[132:135], v[108:115], v5
    s_waitcnt lgkmcnt(0)
    v_exp_f32 v92, v92
    v_exp_f32 v93, v93
    v_smfmac_f32_32x32x32_bf16 v[60:75], v[136:139], v[116:123], v5
    s_xor_b32 s25, s41, 65536
    buffer_load_dwordx4 v[144:147], v1, s[8:11], s25 offen sc1
    s_add_u32 m0, s40, 24576
    s_xor_b32 s27, s41, 99328
    buffer_load_dwordx4 v1, s[8:11], s27 offen sc1 lds
    v_exp_f32 v94, v94
    v_exp_f32 v95, v95
    v_mfma_f32_32x32x16_bf16 v[108:123], v[148:151], v[80:83], 0
    v_exp_f32 v96, v96
    v_exp_f32 v97, v97
    v_exp_f32 v98, v98
    v_exp_f32 v99, v99
    v_exp_f32 v100, v100
    v_exp_f32 v101, v101
    v_exp_f32 v102, v102
    v_exp_f32 v103, v103
    v_exp_f32 v104, v104
    v_exp_f32 v105, v105
    v_exp_f32 v106, v106
    v_exp_f32 v107, v107
    v_smfmac_f32_32x32x32_bf16 v[12:27], v[124:127], v[92:99], v5
    v_exp_f32 v108, v108
    v_exp_f32 v109, v109
    v_smfmac_f32_32x32x32_bf16 v[12:27], v[128:131], v[100:107], v5
    s_cmp_ge_u32 s20, 4
    s_cbranch_scc1 K_nomark
    buffer_store_dwordx4 v[156:159], v1, s[8:11], s49 offen sc1
    buffer_store_dwordx4 v[156:159], v1, s[8:11], s49 offen offset:2048 sc1
    s_cmp_ge_u32 s22, 28
    s_cbranch_scc1 K_nomark
    buffer_store_dwordx4 v[156:159], v1, s[8:11], s50 offen sc1
    buffer_store_dwordx4 v[156:159], v1, s[8:11], s50 offen offset:1024 sc1
K_nomark:
    s_waitcnt vmcnt(6)
    s_mov_b64 exec, s[42:43]
    ds_read_b128 v[132:135], v3 offset:57344
    ds_read_b128 v[136:139], v3 offset:57856
    s_mov_b64 exec, -1
    v_exp_f32 v110, v110
    v_exp_f32 v111, v111
    v_mfma_f32_32x32x16_bf16 v[92:107], v[148:151], v[84:87], 0
    v_exp_f32 v112, v112
    v_exp_f32 v113, v113
    v_exp_f32 v114, v114
    v_exp_f32 v115, v115
    v_exp_f32 v116, v116
    v_exp_f32 v117, v117
    v_exp_f32 v118, v118
    v_exp_f32 v119, v119
    v_exp_f32 v120, v120
    v_exp_f32 v121, v121
    v_exp_f32 v122, v122
    v_exp_f32 v123, v123
    v_smfmac_f32_32x32x32_bf16 v[28:43], v[124:127], v[108:115], v5
    v_exp_f32 v92, v92
    v_exp_f32 v93, v93
    v_smfmac_f32_32x32x32_bf16 v[28:43], v[128:131], v[116:123], v5
    s_add_u32 m0, s40, 32768
    s_xor_b32 s27, s41, 115712
    buffer_load_dwordx4 v1, s[8:11], s27 offen sc1 lds
    v_exp_f32 v94, v94
    v_exp_f32 v95, v95
    v_mfma_f32_32x32x16_bf16 v[108:123], v[148:151], v[88:91], 0
    v_exp_f32 v96, v96
    v_exp_f32 v97, v97
    v_exp_f32 v98, v98
    v_exp_f32 v99, v99
    v_exp_f32 v100, v100
    v_exp_f32 v101, v101
    v_exp_f32 v102, v102
    v_exp_f32 v103, v103
    v_exp_f32 v104, v104
    v_exp_f32 v105, v105
    v_exp_f32 v106, v106
    v_exp_f32 v107, v107
    v_smfmac_f32_32x32x32_bf16 v[44:59], v[124:127], v[92:99], v5
    v_exp_f32 v108, v108
    v_exp_f32 v109, v109
    v_smfmac_f32_32x32x32_bf16 v[44:59], v[128:131], v[100:107], v5
    v_exp_f32 v110, v110
    v_exp_f32 v111, v111
    v_mfma_f32_32x32x16_bf16 v[92:107], v[152:155], v[76:79], 0
    v_exp_f32 v112, v112
    v_exp_f32 v113, v113
    v_exp_f32 v114, v114
    v_exp_f32 v115, v115
    v_exp_f32 v116, v116
    v_exp_f32 v117, v117
    v_exp_f32 v118, v118
    v_exp_f32 v119, v119
    v_exp_f32 v120, v120
    v_exp_f32 v121, v121
    v_exp_f32 v122, v122
    v_exp_f32 v123, v123
    v_smfmac_f32_32x32x32_bf16 v[60:75], v[124:127], v[108:115], v5
    s_waitcnt lgkmcnt(0)
    v_exp_f32 v92, v92
    v_exp_f32 v93, v93
    v_smfmac_f32_32x32x32_bf16 v[60:75], v[128:131], v[116:123], v5
    s_xor_b32 s25, s41, 81920
    buffer_load_dwordx4 v[148:151], v1, s[8:11], s25 offen sc1
    v_exp_f32 v94, v94
    v_exp_f32 v95, v95
    v_mfma_f32_32x32x16_bf16 v[108:123], v[152:155], v[80:83], 0
    v_exp_f32 v96, v96
    v_exp_f32 v97, v97
    v_exp_f32 v98, v98
    v_exp_f32 v99, v99
    v_exp_f32 v100, v100
    v_exp_f32 v101, v101
    v_exp_f32 v102, v102
    v_exp_f32 v103, v103
    v_exp_f32 v104, v104
    v_exp_f32 v105, v105
    v_exp_f32 v106, v106
    v_exp_f32 v107, v107
    v_smfmac_f32_32x32x32_bf16 v[12:27], v[132:135], v[92:99], v5
    v_exp_f32 v108, v108
    v_exp_f32 v109, v109
    v_smfmac_f32_32x32x32_bf16 v[12:27], v[136:139], v[100:107], v5
    s_waitcnt vmcnt(6)
    s_mov_b64 exec, s[42:43]
    ds_read_b128 v[124:127], v3 offset:0
    ds_read_b128 v[128:131], v3 offset:512
    s_mov_b64 exec, -1
    v_exp_f32 v110, v110
    v_exp_f32 v111, v111
    v_mfma_f32_32x32x16_bf16 v[92:107], v[152:155], v[84:87], 0
    v_exp_f32 v112, v112
    v_exp_f32 v113, v113
    v_exp_f32 v114, v114
    v_exp_f32 v115, v115
    v_exp_f32 v116, v116
    v_exp_f32 v117, v117
    v_exp_f32 v118, v118
    v_exp_f32 v119, v119
    v_exp_f32 v120, v120
    v_exp_f32 v121, v121
    v_exp_f32 v122, v122
    v_exp_f32 v123, v123
    v_smfmac_f32_32x32x32_bf16 v[28:43], v[132:135], v[108:115], v5
    v_exp_f32 v92, v92
    v_exp_f32 v93, v93
    v_smfmac_f32_32x32x32_bf16 v[28:43], v[136:139], v[116:123], v5
    v_exp_f32 v94, v94
    v_exp_f32 v95, v95
    v_mfma_f32_32x32x16_bf16 v[108:123], v[152:155], v[88:91], 0
    v_exp_f32 v96, v96
    v_exp_f32 v97, v97
    v_exp_f32 v98, v98
    v_exp_f32 v99, v99
    v_exp_f32 v100, v100
    v_exp_f32 v101, v101
    v_exp_f32 v102, v102
    v_exp_f32 v103, v103
    v_exp_f32 v104, v104
    v_exp_f32 v105, v105
    v_exp_f32 v106, v106
    v_exp_f32 v107, v107
    v_smfmac_f32_32x32x32_bf16 v[44:59], v[132:135], v[92:99], v5
    v_exp_f32 v108, v108
    v_exp_f32 v109, v109
    v_smfmac_f32_32x32x32_bf16 v[44:59], v[136:139], v[100:107], v5
    v_exp_f32 v110, v110
    v_exp_f32 v111, v111
    v_mfma_f32_32x32x16_bf16 v[92:107], v[140:143], v[76:79], 0
    v_exp_f32 v112, v112
    v_exp_f32 v113, v113
    v_exp_f32 v114, v114
    v_exp_f32 v115, v115
    v_exp_f32 v116, v116
    v_exp_f32 v117, v117
    v_exp_f32 v118, v118
    v_exp_f32 v119, v119
    v_exp_f32 v120, v120
    v_exp_f32 v121, v121
    v_exp_f32 v122, v122
    v_exp_f32 v123, v123
    v_smfmac_f32_32x32x32_bf16 v[60:75], v[132:135], v[108:115], v5
    s_waitcnt lgkmcnt(0)
    v_exp_f32 v92, v92
    v_exp_f32 v93, v93
    v_smfmac_f32_32x32x32_bf16 v[60:75], v[136:139], v[116:123], v5
    s_xor_b32 s25, s41, 98304
    buffer_load_dwordx4 v[152:155], v1, s[8:11], s25 offen sc1
    v_exp_f32 v94, v94
    v_exp_f32 v95, v95
    v_mfma_f32_32x32x16_bf16 v[108:123], v[140:143], v[80:83], 0
    v_exp_f32 v96, v96
    v_exp_f32 v97, v97
    v_exp_f32 v98, v98
    v_exp_f32 v99, v99
    v_exp_f32 v100, v100
    v_exp_f32 v101, v101
    v_exp_f32 v102, v102
    v_exp_f32 v103, v103
    v_exp_f32 v104, v104
    v_exp_f32 v105, v105
    v_exp_f32 v106, v106
    v_exp_f32 v107, v107
    v_smfmac_f32_32x32x32_bf16 v[12:27], v[124:127], v[92:99], v5
    v_exp_f32 v108, v108
    v_exp_f32 v109, v109
    v_smfmac_f32_32x32x32_bf16 v[12:27], v[128:131], v[100:107], v5
    s_cmp_lt_u32 s20, 4
    s_cbranch_scc1 K_nomload
    buffer_load_dword v167, v166, s[8:11], s52 offen sc1
K_nomload:
    s_waitcnt vmcnt(6)
    s_mov_b64 exec, s[42:43]
    ds_read_b128 v[132:135], v3 offset:8192
    ds_read_b128 v[136:139], v3 offset:8704
    s_mov_b64 exec, -1
    v_exp_f32 v110, v110
    v_exp_f32 v111, v111
    v_mfma_f32_32x32x16_bf16 v[92:107], v[140:143], v[84:87], 0
    v_exp_f32 v112, v112
    v_exp_f32 v113, v113
    v_exp_f32 v114, v114
    v_exp_f32 v115, v115
    v_exp_f32 v116, v116
    v_exp_f32 v117, v117
    v_exp_f32 v118, v118
    v_exp_f32 v119, v119
    v_exp_f32 v120, v120
    v_exp_f32 v121, v121
    v_exp_f32 v122, v122
    v_exp_f32 v123, v123
    v_smfmac_f32_32x32x32_bf16 v[28:43], v[124:127], v[108:115], v5
    v_exp_f32 v92, v92
    v_exp_f32 v93, v93
    v_smfmac_f32_32x32x32_bf16 v[28:43], v[128:131], v[116:123], v5
    v_exp_f32 v94, v94
    v_exp_f32 v95, v95
    v_mfma_f32_32x32x16_bf16 v[108:123], v[140:143], v[88:91], 0
    v_exp_f32 v96, v96
    v_exp_f32 v97, v97
    v_exp_f32 v98, v98
    v_exp_f32 v99, v99
    v_exp_f32 v100, v100
    v_exp_f32 v101, v101
    v_exp_f32 v102, v102
    v_exp_f32 v103, v103
    v_exp_f32 v104, v104
    v_exp_f32 v105, v105
    v_exp_f32 v106, v106
    v_exp_f32 v107, v107
    v_smfmac_f32_32x32x32_bf16 v[44:59], v[124:127], v[92:99], v5
    v_exp_f32 v108, v108
    v_exp_f32 v109, v109
    v_smfmac_f32_32x32x32_bf16 v[44:59], v[128:131], v[100:107], v5
    v_exp_f32 v110, v110
    v_exp_f32 v111, v111
    s_waitcnt vmcnt(4)
    v_mfma_f32_32x32x16_bf16 v[92:107], v[144:147], v[76:79], 0
    v_exp_f32 v112, v112
    v_exp_f32 v113, v113
    v_exp_f32 v114, v114
    v_exp_f32 v115, v115
    v_exp_f32 v116, v116
    v_exp_f32 v117, v117
    v_exp_f32 v118, v118
    v_exp_f32 v119, v119
    v_exp_f32 v120, v120
    v_exp_f32 v121, v121
    v_exp_f32 v122, v122
    v_exp_f32 v123, v123
    v_smfmac_f32_32x32x32_bf16 v[60:75], v[124:127], v[108:115], v5
    s_waitcnt lgkmcnt(0)
    v_exp_f32 v92, v92
    v_exp_f32 v93, v93
    v_smfmac_f32_32x32x32_bf16 v[60:75], v[128:131], v[116:123], v5
    s_cmp_lt_u32 s20, 4
    s_cbranch_scc1 K_mpoll_ok
    s_branch K_mpoll_t
K_mpoll:
    buffer_load_dword v167, v166, s[8:11], s52 offen sc1
K_mpoll_t:
    s_waitcnt vmcnt(0)
    v_cmp_eq_u32 vcc, 0, v167
    s_cbranch_vccz K_mpoll_ok
    s_cmp_eq_u32 s60, 0
    s_cbranch_scc1 K_mpoll_ok
    s_sub_u32 s60, s60, 1
    s_mov_b64 exec, vcc
    s_sleep 2
    s_branch K_mpoll
K_mpoll_ok:
    s_mov_b64 exec, -1
    s_waitcnt vmcnt(0)
    s_mov_b64 exec, 1
    ds_add_u32 v9, v11
    s_cmp_ge_u32 s20, 4
    s_cbranch_scc1 K_nomark2
    ds_add_rtn_u32 v2, v165, v11 offset:28
    s_waitcnt lgkmcnt(0)
    v_readfirstlane_b32 s35, v2
    s_cmp_lg_u32 s35, 3
    s_cbranch_scc1 K_nomark2
    buffer_store_dword v11, v1, s[8:11], s51 offen offset:8 sc1
K_nomark2:
    s_mov_b64 exec, -1
    s_xor_b32 s25, s41, 114688
    buffer_load_dwordx4 v[140:143], v1, s[8:11], s25 offen sc1
    v_exp_f32 v94, v94
    v_exp_f32 v95, v95
    v_mfma_f32_32x32x16_bf16 v[108:123], v[144:147], v[80:83], 0
    v_exp_f32 v96, v96
    v_exp_f32 v97, v97
    v_exp_f32 v98, v98
    v_exp_f32 v99, v99
    v_exp_f32 v100, v100
    v_exp_f32 v101, v101
    v_exp_f32 v102, v102
    v_exp_f32 v103, v103
    v_exp_f32 v104, v104
    v_exp_f32 v105, v105
    v_exp_f32 v106, v106
    v_exp_f32 v107, v107
    v_smfmac_f32_32x32x32_bf16 v[12:27], v[132:135], v[92:99], v5
    v_exp_f32 v108, v108
    v_exp_f32 v109, v109
    v_smfmac_f32_32x32x32_bf16 v[12:27], v[136:139], v[100:107], v5
    s_mov_b64 exec, s[42:43]
    ds_read_b128 v[124:127], v3 offset:16384
    ds_read_b128 v[128:131], v3 offset:16896
    s_mov_b64 exec, -1
    v_exp_f32 v110, v110
    v_exp_f32 v111, v111
    v_mfma_f32_32x32x16_bf16 v[92:107], v[144:147], v[84:87], 0
    v_exp_f32 v112, v112
    v_exp_f32 v113, v113
    v_exp_f32 v114, v114
    v_exp_f32 v115, v115
    v_exp_f32 v116, v116
    v_exp_f32 v117, v117
    v_exp_f32 v118, v118
    v_exp_f32 v119, v119
    v_exp_f32 v120, v120
    v_exp_f32 v121, v121
    v_exp_f32 v122, v122
    v_exp_f32 v123, v123
    v_smfmac_f32_32x32x32_bf16 v[28:43], v[132:135], v[108:115], v5
    v_exp_f32 v92, v92
    v_exp_f32 v93, v93
    v_smfmac_f32_32x32x32_bf16 v[28:43], v[136:139], v[116:123], v5
    v_exp_f32 v94, v94
    v_exp_f32 v95, v95
    v_mfma_f32_32x32x16_bf16 v[108:123], v[144:147], v[88:91], 0
    v_exp_f32 v96, v96
    v_exp_f32 v97, v97
    v_exp_f32 v98, v98
    v_exp_f32 v99, v99
    v_exp_f32 v100, v100
    v_exp_f32 v101, v101
    v_exp_f32 v102, v102
    v_exp_f32 v103, v103
    v_exp_f32 v104, v104
    v_exp_f32 v105, v105
    v_exp_f32 v106, v106
    v_exp_f32 v107, v107
    v_smfmac_f32_32x32x32_bf16 v[44:59], v[132:135], v[92:99], v5
    v_exp_f32 v108, v108
    v_exp_f32 v109, v109
    v_smfmac_f32_32x32x32_bf16 v[44:59], v[136:139], v[100:107], v5
    v_exp_f32 v110, v110
    v_exp_f32 v111, v111
    v_mfma_f32_32x32x16_bf16 v[92:107], v[148:151], v[76:79], 0
    v_exp_f32 v112, v112
    v_exp_f32 v113, v113
    v_exp_f32 v114, v114
    v_exp_f32 v115, v115
    v_exp_f32 v116, v116
    v_exp_f32 v117, v117
    v_exp_f32 v118, v118
    v_exp_f32 v119, v119
    v_exp_f32 v120, v120
    v_exp_f32 v121, v121
    v_exp_f32 v122, v122
    v_exp_f32 v123, v123
    v_smfmac_f32_32x32x32_bf16 v[60:75], v[132:135], v[108:115], v5
    s_waitcnt lgkmcnt(0)
    s_setprio 2
    v_exp_f32 v92, v92
    v_exp_f32 v93, v93
    v_smfmac_f32_32x32x32_bf16 v[60:75], v[136:139], v[116:123], v5
    s_xor_b32 s25, s41, 18432
    buffer_load_dwordx4 v[144:147], v1, s[8:11], s25 offen sc1
    v_exp_f32 v94, v94
    v_exp_f32 v95, v95
    v_mfma_f32_32x32x16_bf16 v[108:123], v[148:151], v[80:83], 0
    v_exp_f32 v96, v96
    v_exp_f32 v97, v97
    v_exp_f32 v98, v98
    v_exp_f32 v99, v99
    v_exp_f32 v100, v100
    v_exp_f32 v101, v101
    v_exp_f32 v102, v102
    v_exp_f32 v103, v103
    v_exp_f32 v104, v104
    v_exp_f32 v105, v105
    v_exp_f32 v106, v106
    v_exp_f32 v107, v107
    v_smfmac_f32_32x32x32_bf16 v[12:27], v[124:127], v[92:99], v5
    v_exp_f32 v108, v108
    v_exp_f32 v109, v109
    v_smfmac_f32_32x32x32_bf16 v[12:27], v[128:131], v[100:107], v5
    s_mov_b64 exec, s[42:43]
    ds_read_b128 v[132:135], v3 offset:24576
    ds_read_b128 v[136:139], v3 offset:25088
    s_mov_b64 exec, -1
    v_exp_f32 v110, v110
    v_exp_f32 v111, v111
    v_mfma_f32_32x32x16_bf16 v[92:107], v[148:151], v[84:87], 0
    v_exp_f32 v112, v112
    v_exp_f32 v113, v113
    v_exp_f32 v114, v114
    v_exp_f32 v115, v115
    v_exp_f32 v116, v116
    v_exp_f32 v117, v117
    v_exp_f32 v118, v118
    v_exp_f32 v119, v119
    v_exp_f32 v120, v120
    v_exp_f32 v121, v121
    v_exp_f32 v122, v122
    v_exp_f32 v123, v123
    v_smfmac_f32_32x32x32_bf16 v[28:43], v[124:127], v[108:115], v5
    v_exp_f32 v92, v92
    v_exp_f32 v93, v93
    v_smfmac_f32_32x32x32_bf16 v[28:43], v[128:131], v[116:123], v5
    v_exp_f32 v94, v94
    v_exp_f32 v95, v95
    v_mfma_f32_32x32x16_bf16 v[108:123], v[148:151], v[88:91], 0
    v_exp_f32 v96, v96
    v_exp_f32 v97, v97
    v_exp_f32 v98, v98
    v_exp_f32 v99, v99
    v_exp_f32 v100, v100
    v_exp_f32 v101, v101
    v_exp_f32 v102, v102
    v_exp_f32 v103, v103
    v_exp_f32 v104, v104
    v_exp_f32 v105, v105
    v_exp_f32 v106, v106
    v_exp_f32 v107, v107
    v_smfmac_f32_32x32x32_bf16 v[44:59], v[124:127], v[92:99], v5
    v_exp_f32 v108, v108
    v_exp_f32 v109, v109
    v_smfmac_f32_32x32x32_bf16 v[44:59], v[128:131], v[100:107], v5
    v_exp_f32 v110, v110
    v_exp_f32 v111, v111
    v_mfma_f32_32x32x16_bf16 v[92:107], v[152:155], v[76:79], 0
    v_exp_f32 v112, v112
    v_exp_f32 v113, v113
    v_exp_f32 v114, v114
    v_exp_f32 v115, v115
    v_exp_f32 v116, v116
    v_exp_f32 v117, v117
    v_exp_f32 v118, v118
    v_exp_f32 v119, v119
    v_exp_f32 v120, v120
    v_exp_f32 v121, v121
    v_exp_f32 v122, v122
    v_exp_f32 v123, v123
    v_smfmac_f32_32x32x32_bf16 v[60:75], v[124:127], v[108:115], v5
    s_waitcnt lgkmcnt(0)
    v_exp_f32 v92, v92
    v_exp_f32 v93, v93
    v_smfmac_f32_32x32x32_bf16 v[60:75], v[128:131], v[116:123], v5
    s_xor_b32 s25, s41, 34816
    buffer_load_dwordx4 v[148:151], v1, s[8:11], s25 offen sc1
    v_exp_f32 v94, v94
    v_exp_f32 v95, v95
    v_mfma_f32_32x32x16_bf16 v[108:123], v[152:155], v[80:83], 0
    v_exp_f32 v96, v96
    v_exp_f32 v97, v97
    v_exp_f32 v98, v98
    v_exp_f32 v99, v99
    v_exp_f32 v100, v100
    v_exp_f32 v101, v101
    v_exp_f32 v102, v102
    v_exp_f32 v103, v103
    v_exp_f32 v104, v104
    v_exp_f32 v105, v105
    v_exp_f32 v106, v106
    v_exp_f32 v107, v107
    v_smfmac_f32_32x32x32_bf16 v[12:27], v[132:135], v[92:99], v5
    v_exp_f32 v108, v108
    v_exp_f32 v109, v109
    v_smfmac_f32_32x32x32_bf16 v[12:27], v[136:139], v[100:107], v5
    s_mov_b64 exec, s[42:43]
    ds_read_b128 v[124:127], v3 offset:32768
    ds_read_b128 v[128:131], v3 offset:33280
    s_mov_b64 exec, -1
    v_exp_f32 v110, v110
    v_exp_f32 v111, v111
    v_mfma_f32_32x32x16_bf16 v[92:107], v[152:155], v[84:87], 0
    v_exp_f32 v112, v112
    v_exp_f32 v113, v113
    v_exp_f32 v114, v114
    v_exp_f32 v115, v115
    v_exp_f32 v116, v116
    v_exp_f32 v117, v117
    v_exp_f32 v118, v118
    v_exp_f32 v119, v119
    v_exp_f32 v120, v120
    v_exp_f32 v121, v121
    v_exp_f32 v122, v122
    v_exp_f32 v123, v123
    v_smfmac_f32_32x32x32_bf16 v[28:43], v[132:135], v[108:115], v5
    v_exp_f32 v92, v92
    v_exp_f32 v93, v93
    v_smfmac_f32_32x32x32_bf16 v[28:43], v[136:139], v[116:123], v5
    v_exp_f32 v94, v94
    v_exp_f32 v95, v95
    v_mfma_f32_32x32x16_bf16 v[108:123], v[152:155], v[88:91], 0
    v_exp_f32 v96, v96
    v_exp_f32 v97, v97
    v_exp_f32 v98, v98
    v_exp_f32 v99, v99
    v_exp_f32 v100, v100
    v_exp_f32 v101, v101
    v_exp_f32 v102, v102
    v_exp_f32 v103, v103
    v_exp_f32 v104, v104
    v_exp_f32 v105, v105
    v_exp_f32 v106, v106
    v_exp_f32 v107, v107
    v_smfmac_f32_32x32x32_bf16 v[44:59], v[132:135], v[92:99], v5
    v_exp_f32 v108, v108
    v_exp_f32 v109, v109
    v_smfmac_f32_32x32x32_bf16 v[44:59], v[136:139], v[100:107], v5
    v_exp_f32 v110, v110
    v_exp_f32 v111, v111
    s_waitcnt vmcnt(2)
    v_mfma_f32_32x32x16_bf16 v[92:107], v[140:143], v[76:79], 0
    v_exp_f32 v112, v112
    v_exp_f32 v113, v113
    v_exp_f32 v114, v114
    v_exp_f32 v115, v115
    v_exp_f32 v116, v116
    v_exp_f32 v117, v117
    v_exp_f32 v118, v118
    v_exp_f32 v119, v119
    v_exp_f32 v120, v120
    v_exp_f32 v121, v121
    v_exp_f32 v122, v122
    v_exp_f32 v123, v123
    v_smfmac_f32_32x32x32_bf16 v[60:75], v[132:135], v[108:115], v5
    s_waitcnt lgkmcnt(0)
    v_exp_f32 v92, v92
    v_exp_f32 v93, v93
    v_smfmac_f32_32x32x32_bf16 v[60:75], v[136:139], v[116:123], v5
    s_xor_b32 s25, s41, 51200
    buffer_load_dwordx4 v[152:155], v1, s[8:11], s25 offen sc1
    s_mov_b64 exec, 1
    ds_add_u32 v9, v11
    s_mov_b64 exec, -1
    v_exp_f32 v94, v94
    v_exp_f32 v95, v95
    v_mfma_f32_32x32x16_bf16 v[108:123], v[140:143], v[80:83], 0
    v_exp_f32 v96, v96
    v_exp_f32 v97, v97
    v_exp_f32 v98, v98
    v_exp_f32 v99, v99
    v_exp_f32 v100, v100
    v_exp_f32 v101, v101
    v_exp_f32 v102, v102
    v_exp_f32 v103, v103
    v_exp_f32 v104, v104
    v_exp_f32 v105, v105
    v_exp_f32 v106, v106
    v_exp_f32 v107, v107
    v_smfmac_f32_32x32x32_bf16 v[12:27], v[124:127], v[92:99], v5
    v_exp_f32 v108, v108
    v_exp_f32 v109, v109
    v_smfmac_f32_32x32x32_bf16 v[12:27], v[128:131], v[100:107], v5
K_s1:
    ds_read_b32 v2, v10 offset:0
    s_waitcnt lgkmcnt(0)
    v_readfirstlane_b32 s33, v2
    s_cmp_ge_u32 s33, 3
    s_cbranch_scc1 K_s1_ok
    s_sleep 1
    s_branch K_s1
K_s1_ok:
    s_mov_b64 exec, s[42:43]
    ds_read_b128 v[132:135], v4 offset:49152
    ds_read_b128 v[136:139], v4 offset:49664
    s_mov_b64 exec, -1
    v_exp_f32 v110, v110
    v_exp_f32 v111, v111
    v_mfma_f32_32x32x16_bf16 v[92:107], v[140:143], v[84:87], 0
    v_exp_f32 v112, v112
    v_exp_f32 v113, v113
    v_exp_f32 v114, v114
    v_exp_f32 v115, v115
    v_exp_f32 v116, v116
    v_exp_f32 v117, v117
    v_exp_f32 v118, v118
    v_exp_f32 v119, v119
    v_exp_f32 v120, v120
    v_exp_f32 v121, v121
    v_exp_f32 v122, v122
    v_exp_f32 v123, v123
    v_smfmac_f32_32x32x32_bf16 v[28:43], v[124:127], v[108:115], v5
    v_exp_f32 v92, v92
    v_exp_f32 v93, v93
    v_smfmac_f32_32x32x32_bf16 v[28:43], v[128:131], v[116:123], v5
    buffer_load_dword v8, v8, s[8:11], s34 offen sc1
    v_exp_f32 v94, v94
    v_exp_f32 v95, v95
    v_mfma_f32_32x32x16_bf16 v[108:123], v[140:143], v[88:91], 0
    v_exp_f32 v96, v96
    v_exp_f32 v97, v97
    v_exp_f32 v98, v98
    v_exp_f32 v99, v99
    v_exp_f32 v100, v100
    v_exp_f32 v101, v101
    v_exp_f32 v102, v102
    v_exp_f32 v103, v103
    v_exp_f32 v104, v104
    v_exp_f32 v105, v105
    v_exp_f32 v106, v106
    v_exp_f32 v107, v107
    v_smfmac_f32_32x32x32_bf16 v[44:59], v[124:127], v[92:99], v5
    v_exp_f32 v108, v108
    v_exp_f32 v109, v109
    v_smfmac_f32_32x32x32_bf16 v[44:59], v[128:131], v[100:107], v5
    v_exp_f32 v110, v110
    v_exp_f32 v111, v111
    s_waitcnt vmcnt(3)
    v_mfma_f32_32x32x16_bf16 v[92:107], v[144:147], v[76:79], 0
    v_exp_f32 v112, v112
    v_exp_f32 v113, v113
    v_exp_f32 v114, v114
    v_exp_f32 v115, v115
    v_exp_f32 v116, v116
    v_exp_f32 v117, v117
    v_exp_f32 v118, v118
    v_exp_f32 v119, v119
    v_exp_f32 v120, v120
    v_exp_f32 v121, v121
    v_exp_f32 v122, v122
    v_exp_f32 v123, v123
    v_smfmac_f32_32x32x32_bf16 v[60:75], v[124:127], v[108:115], v5
    s_waitcnt lgkmcnt(0)
    v_exp_f32 v92, v92
    v_exp_f32 v93, v93
    v_smfmac_f32_32x32x32_bf16 v[60:75], v[128:131], v[116:123], v5
    s_xor_b32 s25, s41, 67584
    buffer_load_dwordx4 v[140:143], v1, s[8:11], s25 offen sc1
    v_exp_f32 v94, v94
    v_exp_f32 v95, v95
    v_mfma_f32_32x32x16_bf16 v[108:123], v[144:147], v[80:83], 0
    v_exp_f32 v96, v96
    v_exp_f32 v97, v97
    v_exp_f32 v98, v98
    v_exp_f32 v99, v99
    v_exp_f32 v100, v100
    v_exp_f32 v101, v101
    v_exp_f32 v102, v102
    v_exp_f32 v103, v103
    v_exp_f32 v104, v104
    v_exp_f32 v105, v105
    v_exp_f32 v106, v106
    v_exp_f32 v107, v107
    v_smfmac_f32_32x32x32_bf16 v[12:27], v[132:135], v[92:99], v5
    v_exp_f32 v108, v108
    v_exp_f32 v109, v109
    v_smfmac_f32_32x32x32_bf16 v[12:27], v[136:139], v[100:107], v5
    s_mov_b64 exec, s[42:43]
    ds_read_b128 v[124:127], v4 offset:57344
    ds_read_b128 v[128:131], v4 offset:57856
    s_mov_b64 exec, -1
    v_exp_f32 v110, v110
    v_exp_f32 v111, v111
    v_mfma_f32_32x32x16_bf16 v[92:107], v[144:147], v[84:87], 0
    v_exp_f32 v112, v112
    v_exp_f32 v113, v113
    v_exp_f32 v114, v114
    v_exp_f32 v115, v115
    v_exp_f32 v116, v116
    v_exp_f32 v117, v117
    v_exp_f32 v118, v118
    v_exp_f32 v119, v119
    v_exp_f32 v120, v120
    v_exp_f32 v121, v121
    v_exp_f32 v122, v122
    v_exp_f32 v123, v123
    v_smfmac_f32_32x32x32_bf16 v[28:43], v[132:135], v[108:115], v5
    v_exp_f32 v92, v92
    v_exp_f32 v93, v93
    v_smfmac_f32_32x32x32_bf16 v[28:43], v[136:139], v[116:123], v5
    v_exp_f32 v94, v94
    v_exp_f32 v95, v95
    v_mfma_f32_32x32x16_bf16 v[108:123], v[144:147], v[88:91], 0
    v_exp_f32 v96, v96
    v_exp_f32 v97, v97
    v_exp_f32 v98, v98
    v_exp_f32 v99, v99
    v_exp_f32 v100, v100
    v_exp_f32 v101, v101
    v_exp_f32 v102, v102
    v_exp_f32 v103, v103
    v_exp_f32 v104, v104
    v_exp_f32 v105, v105
    v_exp_f32 v106, v106
    v_exp_f32 v107, v107
    v_smfmac_f32_32x32x32_bf16 v[44:59], v[132:135], v[92:99], v5
    v_exp_f32 v108, v108
    v_exp_f32 v109, v109
    v_smfmac_f32_32x32x32_bf16 v[44:59], v[136:139], v[100:107], v5
    v_exp_f32 v110, v110
    v_exp_f32 v111, v111
    s_waitcnt vmcnt(3)
    v_mfma_f32_32x32x16_bf16 v[92:107], v[148:151], v[76:79], 0
    v_exp_f32 v112, v112
    v_exp_f32 v113, v113
    v_exp_f32 v114, v114
    v_exp_f32 v115, v115
    v_exp_f32 v116, v116
    v_exp_f32 v117, v117
    v_exp_f32 v118, v118
    v_exp_f32 v119, v119
    v_exp_f32 v120, v120
    v_exp_f32 v121, v121
    v_exp_f32 v122, v122
    v_exp_f32 v123, v123
    v_smfmac_f32_32x32x32_bf16 v[60:75], v[132:135], v[108:115], v5
    s_waitcnt lgkmcnt(0)
    v_exp_f32 v92, v92
    v_exp_f32 v93, v93
    v_smfmac_f32_32x32x32_bf16 v[60:75], v[136:139], v[116:123], v5
    s_xor_b32 s25, s41, 83968
    buffer_load_dwordx4 v[144:147], v1, s[8:11], s25 offen sc1
    v_exp_f32 v94, v94
    v_exp_f32 v95, v95
    v_mfma_f32_32x32x16_bf16 v[108:123], v[148:151], v[80:83], 0
    v_exp_f32 v96, v96
    v_exp_f32 v97, v97
    v_exp_f32 v98, v98
    v_exp_f32 v99, v99
    v_exp_f32 v100, v100
    v_exp_f32 v101, v101
    v_exp_f32 v102, v102
    v_exp_f32 v103, v103
    v_exp_f32 v104, v104
    v_exp_f32 v105, v105
    v_exp_f32 v106, v106
    v_exp_f32 v107, v107
    v_smfmac_f32_32x32x32_bf16 v[12:27], v[124:127], v[92:99], v5
    v_exp_f32 v108, v108
    v_exp_f32 v109, v109
    v_smfmac_f32_32x32x32_bf16 v[12:27], v[128:131], v[100:107], v5
    s_mov_b64 exec, s[42:43]
    ds_read_b128 v[132:135], v4 offset:0
    ds_read_b128 v[136:139], v4 offset:512
    s_mov_b64 exec, -1
    v_exp_f32 v110, v110
    v_exp_f32 v111, v111
    v_mfma_f32_32x32x16_bf16 v[92:107], v[148:151], v[84:87], 0
    v_exp_f32 v112, v112
    v_exp_f32 v113, v113
    v_exp_f32 v114, v114
    v_exp_f32 v115, v115
    v_exp_f32 v116, v116
    v_exp_f32 v117, v117
    v_exp_f32 v118, v118
    v_exp_f32 v119, v119
    v_exp_f32 v120, v120
    v_exp_f32 v121, v121
    v_exp_f32 v122, v122
    v_exp_f32 v123, v123
    v_smfmac_f32_32x32x32_bf16 v[28:43], v[124:127], v[108:115], v5
    v_exp_f32 v92, v92
    v_exp_f32 v93, v93
    v_smfmac_f32_32x32x32_bf16 v[28:43], v[128:131], v[116:123], v5
    v_exp_f32 v94, v94
    v_exp_f32 v95, v95
    v_mfma_f32_32x32x16_bf16 v[108:123], v[148:151], v[88:91], 0
    v_exp_f32 v96, v96
    v_exp_f32 v97, v97
    v_exp_f32 v98, v98
    v_exp_f32 v99, v99
    v_exp_f32 v100, v100
    v_exp_f32 v101, v101
    v_exp_f32 v102, v102
    v_exp_f32 v103, v103
    v_exp_f32 v104, v104
    v_exp_f32 v105, v105
    v_exp_f32 v106, v106
    v_exp_f32 v107, v107
    v_smfmac_f32_32x32x32_bf16 v[44:59], v[124:127], v[92:99], v5
    v_exp_f32 v108, v108
    v_exp_f32 v109, v109
    v_smfmac_f32_32x32x32_bf16 v[44:59], v[128:131], v[100:107], v5
    v_exp_f32 v110, v110
    v_exp_f32 v111, v111
    s_waitcnt vmcnt(3)
    v_mfma_f32_32x32x16_bf16 v[92:107], v[152:155], v[76:79], 0
    v_exp_f32 v112, v112
    v_exp_f32 v113, v113
    v_exp_f32 v114, v114
    v_exp_f32 v115, v115
    v_exp_f32 v116, v116
    v_exp_f32 v117, v117
    v_exp_f32 v118, v118
    v_exp_f32 v119, v119
    v_exp_f32 v120, v120
    v_exp_f32 v121, v121
    v_exp_f32 v122, v122
    v_exp_f32 v123, v123
    v_smfmac_f32_32x32x32_bf16 v[60:75], v[124:127], v[108:115], v5
    s_waitcnt lgkmcnt(0)
    v_exp_f32 v92, v92
    v_exp_f32 v93, v93
    v_smfmac_f32_32x32x32_bf16 v[60:75], v[128:131], v[116:123], v5
    s_xor_b32 s25, s41, 100352
    buffer_load_dwordx4 v[148:151], v1, s[8:11], s25 offen sc1
    v_exp_f32 v94, v94
    v_exp_f32 v95, v95
    v_mfma_f32_32x32x16_bf16 v[108:123], v[152:155], v[80:83], 0
    v_exp_f32 v96, v96
    v_exp_f32 v97, v97
    v_exp_f32 v98, v98
    v_exp_f32 v99, v99
    v_exp_f32 v100, v100
    v_exp_f32 v101, v101
    v_exp_f32 v102, v102
    v_exp_f32 v103, v103
    v_exp_f32 v104, v104
    v_exp_f32 v105, v105
    v_exp_f32 v106, v106
    v_exp_f32 v107, v107
    v_smfmac_f32_32x32x32_bf16 v[12:27], v[132:135], v[92:99], v5
    v_exp_f32 v108, v108
    v_exp_f32 v109, v109
    v_smfmac_f32_32x32x32_bf16 v[12:27], v[136:139], v[100:107], v5
    s_mov_b64 exec, s[42:43]
    ds_read_b128 v[124:127], v4 offset:8192
    ds_read_b128 v[128:131], v4 offset:8704
    s_mov_b64 exec, -1
    v_exp_f32 v110, v110
    v_exp_f32 v111, v111
    v_mfma_f32_32x32x16_bf16 v[92:107], v[152:155], v[84:87], 0
    v_exp_f32 v112, v112
    v_exp_f32 v113, v113
    v_exp_f32 v114, v114
    v_exp_f32 v115, v115
    v_exp_f32 v116, v116
    v_exp_f32 v117, v117
    v_exp_f32 v118, v118
    v_exp_f32 v119, v119
    v_exp_f32 v120, v120
    v_exp_f32 v121, v121
    v_exp_f32 v122, v122
    v_exp_f32 v123, v123
    v_smfmac_f32_32x32x32_bf16 v[28:43], v[132:135], v[108:115], v5
    v_exp_f32 v92, v92
    v_exp_f32 v93, v93
    v_smfmac_f32_32x32x32_bf16 v[28:43], v[136:139], v[116:123], v5
    v_exp_f32 v94, v94
    v_exp_f32 v95, v95
    v_mfma_f32_32x32x16_bf16 v[108:123], v[152:155], v[88:91], 0
    v_exp_f32 v96, v96
    v_exp_f32 v97, v97
    v_exp_f32 v98, v98
    v_exp_f32 v99, v99
    v_exp_f32 v100, v100
    v_exp_f32 v101, v101
    v_exp_f32 v102, v102
    v_exp_f32 v103, v103
    v_exp_f32 v104, v104
    v_exp_f32 v105, v105
    v_exp_f32 v106, v106
    v_exp_f32 v107, v107
    v_smfmac_f32_32x32x32_bf16 v[44:59], v[132:135], v[92:99], v5
    v_exp_f32 v108, v108
    v_exp_f32 v109, v109
    v_smfmac_f32_32x32x32_bf16 v[44:59], v[136:139], v[100:107], v5
    v_exp_f32 v110, v110
    v_exp_f32 v111, v111
    s_waitcnt vmcnt(2)
    v_mfma_f32_32x32x16_bf16 v[92:107], v[140:143], v[76:79], 0
    v_exp_f32 v112, v112
    v_exp_f32 v113, v113
    v_exp_f32 v114, v114
    v_exp_f32 v115, v115
    v_exp_f32 v116, v116
    v_exp_f32 v117, v117
    v_exp_f32 v118, v118
    v_exp_f32 v119, v119
    v_exp_f32 v120, v120
    v_exp_f32 v121, v121
    v_exp_f32 v122, v122
    v_exp_f32 v123, v123
    v_smfmac_f32_32x32x32_bf16 v[60:75], v[132:135], v[108:115], v5
    s_waitcnt lgkmcnt(0)
    s_setprio 1
    v_exp_f32 v92, v92
    v_exp_f32 v93, v93
    v_smfmac_f32_32x32x32_bf16 v[60:75], v[136:139], v[116:123], v5
    s_xor_b32 s25, s41, 116736
    buffer_load_dwordx4 v[152:155], v1, s[8:11], s25 offen sc1
    v_exp_f32 v94, v94
    v_exp_f32 v95, v95
    v_mfma_f32_32x32x16_bf16 v[108:123], v[140:143], v[80:83], 0
    v_exp_f32 v96, v96
    v_exp_f32 v97, v97
    v_exp_f32 v98, v98
    v_exp_f32 v99, v99
    v_exp_f32 v100, v100
    v_exp_f32 v101, v101
    v_exp_f32 v102, v102
    v_exp_f32 v103, v103
    v_exp_f32 v104, v104
    v_exp_f32 v105, v105
    v_exp_f32 v106, v106
    v_exp_f32 v107, v107
    v_smfmac_f32_32x32x32_bf16 v[12:27], v[124:127], v[92:99], v5
    v_exp_f32 v108, v108
    v_exp_f32 v109, v109
    v_smfmac_f32_32x32x32_bf16 v[12:27], v[128:131], v[100:107], v5
    s_mov_b64 exec, s[42:43]
    ds_read_b128 v[132:135], v4 offset:16384
    ds_read_b128 v[136:139], v4 offset:16896
    s_mov_b64 exec, -1
    v_exp_f32 v110, v110
    v_exp_f32 v111, v111
    v_mfma_f32_32x32x16_bf16 v[92:107], v[140:143], v[84:87], 0
    v_exp_f32 v112, v112
    v_exp_f32 v113, v113
    v_exp_f32 v114, v114
    v_exp_f32 v115, v115
    v_exp_f32 v116, v116
    v_exp_f32 v117, v117
    v_exp_f32 v118, v118
    v_exp_f32 v119, v119
    v_exp_f32 v120, v120
    v_exp_f32 v121, v121
    v_exp_f32 v122, v122
    v_exp_f32 v123, v123
    v_smfmac_f32_32x32x32_bf16 v[28:43], v[124:127], v[108:115], v5
    v_exp_f32 v92, v92
    v_exp_f32 v93, v93
    v_smfmac_f32_32x32x32_bf16 v[28:43], v[128:131], v[116:123], v5
    v_exp_f32 v94, v94
    v_exp_f32 v95, v95
    v_mfma_f32_32x32x16_bf16 v[108:123], v[140:143], v[88:91], 0
    v_exp_f32 v96, v96
    v_exp_f32 v97, v97
    v_exp_f32 v98, v98
    v_exp_f32 v99, v99
    v_exp_f32 v100, v100
    v_exp_f32 v101, v101
    v_exp_f32 v102, v102
    v_exp_f32 v103, v103
    v_exp_f32 v104, v104
    v_exp_f32 v105, v105
    v_exp_f32 v106, v106
    v_exp_f32 v107, v107
    v_smfmac_f32_32x32x32_bf16 v[44:59], v[124:127], v[92:99], v5
    v_exp_f32 v108, v108
    v_exp_f32 v109, v109
    v_smfmac_f32_32x32x32_bf16 v[44:59], v[128:131], v[100:107], v5
    v_exp_f32 v110, v110
    v_exp_f32 v111, v111
    s_waitcnt vmcnt(2)
    v_mfma_f32_32x32x16_bf16 v[92:107], v[144:147], v[76:79], 0
    v_exp_f32 v112, v112
    v_exp_f32 v113, v113
    v_exp_f32 v114, v114
    v_exp_f32 v115, v115
    v_exp_f32 v116, v116
    v_exp_f32 v117, v117
    v_exp_f32 v118, v118
    v_exp_f32 v119, v119
    v_exp_f32 v120, v120
    v_exp_f32 v121, v121
    v_exp_f32 v122, v122
    v_exp_f32 v123, v123
    v_smfmac_f32_32x32x32_bf16 v[60:75], v[124:127], v[108:115], v5
    s_waitcnt lgkmcnt(0)
    v_exp_f32 v92, v92
    v_exp_f32 v93, v93
    v_smfmac_f32_32x32x32_bf16 v[60:75], v[128:131], v[116:123], v5
    v_exp_f32 v94, v94
    v_exp_f32 v95, v95
    v_mfma_f32_32x32x16_bf16 v[108:123], v[144:147], v[80:83], 0
    v_exp_f32 v96, v96
    v_exp_f32 v97, v97
    v_exp_f32 v98, v98
    v_exp_f32 v99, v99
    v_exp_f32 v100, v100
    v_exp_f32 v101, v101
    v_exp_f32 v102, v102
    v_exp_f32 v103, v103
    v_exp_f32 v104, v104
    v_exp_f32 v105, v105
    v_exp_f32 v106, v106
    v_exp_f32 v107, v107
    v_smfmac_f32_32x32x32_bf16 v[12:27], v[132:135], v[92:99], v5
    v_exp_f32 v108, v108
    v_exp_f32 v109, v109
    v_smfmac_f32_32x32x32_bf16 v[12:27], v[136:139], v[100:107], v5
    s_mov_b64 exec, s[42:43]
    ds_read_b128 v[124:127], v4 offset:24576
    ds_read_b128 v[128:131], v4 offset:25088
    s_mov_b64 exec, -1
    v_exp_f32 v110, v110
    v_exp_f32 v111, v111
    v_mfma_f32_32x32x16_bf16 v[92:107], v[144:147], v[84:87], 0
    v_exp_f32 v112, v112
    v_exp_f32 v113, v113
    v_exp_f32 v114, v114
    v_exp_f32 v115, v115
    v_exp_f32 v116, v116
    v_exp_f32 v117, v117
    v_exp_f32 v118, v118
    v_exp_f32 v119, v119
    v_exp_f32 v120, v120
    v_exp_f32 v121, v121
    v_exp_f32 v122, v122
    v_exp_f32 v123, v123
    v_smfmac_f32_32x32x32_bf16 v[28:43], v[132:135], v[108:115], v5
    v_exp_f32 v92, v92
    v_exp_f32 v93, v93
    v_smfmac_f32_32x32x32_bf16 v[28:43], v[136:139], v[116:123], v5
    v_exp_f32 v94, v94
    v_exp_f32 v95, v95
    v_mfma_f32_32x32x16_bf16 v[108:123], v[144:147], v[88:91], 0
    v_exp_f32 v96, v96
    v_exp_f32 v97, v97
    v_exp_f32 v98, v98
    v_exp_f32 v99, v99
    v_exp_f32 v100, v100
    v_exp_f32 v101, v101
    v_exp_f32 v102, v102
    v_exp_f32 v103, v103
    v_exp_f32 v104, v104
    v_exp_f32 v105, v105
    v_exp_f32 v106, v106
    v_exp_f32 v107, v107
    v_smfmac_f32_32x32x32_bf16 v[44:59], v[132:135], v[92:99], v5
    v_exp_f32 v108, v108
    v_exp_f32 v109, v109
    v_smfmac_f32_32x32x32_bf16 v[44:59], v[136:139], v[100:107], v5
    v_exp_f32 v110, v110
    v_exp_f32 v111, v111
    s_waitcnt vmcnt(1)
    v_mfma_f32_32x32x16_bf16 v[92:107], v[148:151], v[76:79], 0
    v_exp_f32 v112, v112
    v_exp_f32 v113, v113
    v_exp_f32 v114, v114
    v_exp_f32 v115, v115
    v_exp_f32 v116, v116
    v_exp_f32 v117, v117
    v_exp_f32 v118, v118
    v_exp_f32 v119, v119
    v_exp_f32 v120, v120
    v_exp_f32 v121, v121
    v_exp_f32 v122, v122
    v_exp_f32 v123, v123
    v_smfmac_f32_32x32x32_bf16 v[60:75], v[132:135], v[108:115], v5
    s_waitcnt lgkmcnt(0)
    v_exp_f32 v92, v92
    v_exp_f32 v93, v93
    v_smfmac_f32_32x32x32_bf16 v[60:75], v[136:139], v[116:123], v5
    v_exp_f32 v94, v94
    v_exp_f32 v95, v95
    v_mfma_f32_32x32x16_bf16 v[108:123], v[148:151], v[80:83], 0
    v_exp_f32 v96, v96
    v_exp_f32 v97, v97
    v_exp_f32 v98, v98
    v_exp_f32 v99, v99
    v_exp_f32 v100, v100
    v_exp_f32 v101, v101
    v_exp_f32 v102, v102
    v_exp_f32 v103, v103
    v_exp_f32 v104, v104
    v_exp_f32 v105, v105
    v_exp_f32 v106, v106
    v_exp_f32 v107, v107
    v_smfmac_f32_32x32x32_bf16 v[12:27], v[124:127], v[92:99], v5
    v_exp_f32 v108, v108
    v_exp_f32 v109, v109
    v_smfmac_f32_32x32x32_bf16 v[12:27], v[128:131], v[100:107], v5
    s_mov_b64 exec, s[42:43]
    ds_read_b128 v[132:135], v4 offset:32768
    ds_read_b128 v[136:139], v4 offset:33280
    s_mov_b64 exec, -1
    v_exp_f32 v110, v110
    v_exp_f32 v111, v111
    v_mfma_f32_32x32x16_bf16 v[92:107], v[148:151], v[84:87], 0
    v_exp_f32 v112, v112
    v_exp_f32 v113, v113
    v_exp_f32 v114, v114
    v_exp_f32 v115, v115
    v_exp_f32 v116, v116
    v_exp_f32 v117, v117
    v_exp_f32 v118, v118
    v_exp_f32 v119, v119
    v_exp_f32 v120, v120
    v_exp_f32 v121, v121
    v_exp_f32 v122, v122
    v_exp_f32 v123, v123
    v_smfmac_f32_32x32x32_bf16 v[28:43], v[124:127], v[108:115], v5
    v_exp_f32 v92, v92
    v_exp_f32 v93, v93
    v_smfmac_f32_32x32x32_bf16 v[28:43], v[128:131], v[116:123], v5
    v_exp_f32 v94, v94
    v_exp_f32 v95, v95
    v_mfma_f32_32x32x16_bf16 v[108:123], v[148:151], v[88:91], 0
    v_exp_f32 v96, v96
    v_exp_f32 v97, v97
    v_exp_f32 v98, v98
    v_exp_f32 v99, v99
    v_exp_f32 v100, v100
    v_exp_f32 v101, v101
    v_exp_f32 v102, v102
    v_exp_f32 v103, v103
    v_exp_f32 v104, v104
    v_exp_f32 v105, v105
    v_exp_f32 v106, v106
    v_exp_f32 v107, v107
    v_smfmac_f32_32x32x32_bf16 v[44:59], v[124:127], v[92:99], v5
    v_exp_f32 v108, v108
    v_exp_f32 v109, v109
    v_smfmac_f32_32x32x32_bf16 v[44:59], v[128:131], v[100:107], v5
    v_exp_f32 v110, v110
    v_exp_f32 v111, v111
    s_waitcnt vmcnt(0)
    v_mfma_f32_32x32x16_bf16 v[92:107], v[152:155], v[76:79], 0
    v_exp_f32 v112, v112
    v_exp_f32 v113, v113
    v_exp_f32 v114, v114
    v_exp_f32 v115, v115
    v_exp_f32 v116, v116
    v_exp_f32 v117, v117
    v_exp_f32 v118, v118
    v_exp_f32 v119, v119
    v_exp_f32 v120, v120
    v_exp_f32 v121, v121
    v_exp_f32 v122, v122
    v_exp_f32 v123, v123
    v_smfmac_f32_32x32x32_bf16 v[60:75], v[124:127], v[108:115], v5
    s_waitcnt lgkmcnt(0)
    v_exp_f32 v92, v92
    v_exp_f32 v93, v93
    v_smfmac_f32_32x32x32_bf16 v[60:75], v[128:131], v[116:123], v5
K_s2:
    ds_read_b32 v2, v10 offset:0
    s_waitcnt lgkmcnt(0)
    v_readfirstlane_b32 s33, v2
    s_cmp_ge_u32 s33, 4
    s_cbranch_scc1 K_s2_ok
    s_sleep 1
    s_branch K_s2
K_s2_ok:
    v_exp_f32 v94, v94
    v_exp_f32 v95, v95
    v_mfma_f32_32x32x16_bf16 v[108:123], v[152:155], v[80:83], 0
    v_exp_f32 v96, v96
    v_exp_f32 v97, v97
    v_exp_f32 v98, v98
    v_exp_f32 v99, v99
    v_exp_f32 v100, v100
    v_exp_f32 v101, v101
    v_smfmac_f32_32x32x32_bf16 v[12:27], v[132:135], v[92:99], v5
    v_exp_f32 v102, v102
    v_exp_f32 v103, v103
    v_exp_f32 v104, v104
    v_exp_f32 v105, v105
    v_exp_f32 v106, v106
    v_exp_f32 v107, v107
    v_exp_f32 v108, v108
    v_exp_f32 v109, v109
    v_smfmac_f32_32x32x32_bf16 v[12:27], v[136:139], v[100:107], v5
    v_exp_f32 v110, v110
    v_exp_f32 v111, v111
    v_mfma_f32_32x32x16_bf16 v[92:107], v[152:155], v[84:87], 0
    v_exp_f32 v112, v112
    v_exp_f32 v113, v113
    v_exp_f32 v114, v114
    v_exp_f32 v115, v115
    v_exp_f32 v116, v116
    v_exp_f32 v117, v117
    v_smfmac_f32_32x32x32_bf16 v[28:43], v[132:135], v[108:115], v5
    v_exp_f32 v118, v118
    v_exp_f32 v119, v119
    v_exp_f32 v120, v120
    v_exp_f32 v121, v121
    ds_write_b128 v6, v[12:15] offset:0
    v_exp_f32 v122, v122
    ds_write_b128 v6, v[16:19] offset:8192
    v_exp_f32 v123, v123
    ds_write_b32 v7, v20 offset:49152
    v_exp_f32 v92, v92
    v_exp_f32 v93, v93
    v_smfmac_f32_32x32x32_bf16 v[28:43], v[136:139], v[116:123], v5
    v_exp_f32 v94, v94
    v_exp_f32 v95, v95
    v_mfma_f32_32x32x16_bf16 v[108:123], v[152:155], v[88:91], 0
    v_exp_f32 v96, v96
    v_exp_f32 v97, v97
    v_exp_f32 v98, v98
    v_exp_f32 v99, v99
    v_exp_f32 v100, v100
    v_exp_f32 v101, v101
    v_smfmac_f32_32x32x32_bf16 v[44:59], v[132:135], v[92:99], v5
    v_exp_f32 v102, v102
    v_exp_f32 v103, v103
    v_exp_f32 v104, v104
    v_exp_f32 v105, v105
    ds_write_b128 v6, v[28:31] offset:16384
    v_exp_f32 v106, v106
    ds_write_b128 v6, v[32:35] offset:24576
    v_exp_f32 v107, v107
    ds_write_b32 v7, v36 offset:49408
    v_exp_f32 v108, v108
    v_exp_f32 v109, v109
    v_smfmac_f32_32x32x32_bf16 v[44:59], v[136:139], v[100:107], v5
    v_exp_f32 v110, v110
    v_exp_f32 v111, v111
    v_exp_f32 v112, v112
    v_exp_f32 v113, v113
    v_exp_f32 v114, v114
    v_exp_f32 v115, v115
    v_exp_f32 v116, v116
    v_exp_f32 v117, v117
    v_smfmac_f32_32x32x32_bf16 v[60:75], v[132:135], v[108:115], v5
    v_exp_f32 v118, v118
    v_exp_f32 v119, v119
    v_exp_f32 v120, v120
    v_exp_f32 v121, v121
    ds_write_b128 v6, v[44:47] offset:32768
    v_exp_f32 v122, v122
    ds_write_b128 v6, v[48:51] offset:40960
    v_exp_f32 v123, v123
    ds_write_b32 v7, v52 offset:49664
    s_waitcnt lgkmcnt(0)
    v_smfmac_f32_32x32x32_bf16 v[60:75], v[136:139], v[116:123], v5
    s_mov_b64 exec, 1
    ds_add_u32 v157, v11
    s_mov_b64 exec, -1
K_aspin:
    ds_read_b32 v85, v157 offset:0
    s_waitcnt lgkmcnt(0)
    v_readfirstlane_b32 s33, v85
    s_cmp_ge_u32 s33, 4
    s_cbranch_scc1 K_aspin_ok
    s_sleep 1
    s_branch K_aspin
K_aspin_ok:
    s_nop 0
    ds_read_b32 v20, v160 offset:49152
    ds_read_b128 v[12:15], v159 offset:0
    ds_read_b128 v[16:19], v159 offset:8192
    ds_read_b32 v36, v162 offset:49408
    ds_read_b128 v[28:31], v161 offset:16384
    ds_read_b128 v[32:35], v161 offset:24576
    ds_read_b32 v52, v164 offset:49664
    ds_read_b128 v[44:47], v163 offset:32768
    ds_read_b128 v[48:51], v163 offset:40960
    s_waitcnt lgkmcnt(6)
    v_add_f32 v68, v68, v20
    v_pk_add_f32 v[60:61], v[60:61], v[12:13]
    v_pk_add_f32 v[62:63], v[62:63], v[14:15]
    v_pk_add_f32 v[64:65], v[64:65], v[16:17]
    v_pk_add_f32 v[66:67], v[66:67], v[18:19]
    s_waitcnt lgkmcnt(3)
    v_add_f32 v68, v68, v36
    v_pk_add_f32 v[60:61], v[60:61], v[28:29]
    v_pk_add_f32 v[62:63], v[62:63], v[30:31]
    v_pk_add_f32 v[64:65], v[64:65], v[32:33]
    v_pk_add_f32 v[66:67], v[66:67], v[34:35]
    s_waitcnt lgkmcnt(0)
    v_add_f32 v68, v68, v52
    v_pk_add_f32 v[60:61], v[60:61], v[44:45]
    v_pk_add_f32 v[62:63], v[62:63], v[46:47]
    v_pk_add_f32 v[64:65], v[64:65], v[48:49]
    v_pk_add_f32 v[66:67], v[66:67], v[50:51]
    v_subrev_u32 v86, s53, v68
    v_cmp_lt_u32 vcc, s54, v86
    s_cbranch_vccnz K_att_slow
K_att_fin:
    v_rcp_f32 v86, v68
    s_nop 0
    v_mul_f32 v86, v8, v86
    v_pk_mul_f32 v[60:61], v[60:61], v[86:87] op_sel_hi:[1,0]
    v_pk_mul_f32 v[62:63], v[62:63], v[86:87] op_sel_hi:[1,0]
    v_pk_mul_f32 v[64:65], v[64:65], v[86:87] op_sel_hi:[1,0]
    v_pk_mul_f32 v[66:67], v[66:67], v[86:87] op_sel_hi:[1,0]
    v_cvt_pk_bf16_f32 v92, v60, v61
    v_cvt_pk_bf16_f32 v93, v62, v63
    v_cvt_pk_bf16_f32 v94, v64, v65
    v_cvt_pk_bf16_f32 v95, v66, v67
    v_min_u32 v92, -2, v92
    buffer_store_dwordx4 v[92:95], v1, s[8:11], s49 offen sc1
    s_mov_b64 exec, 1
    ds_add_u32 v157, v11 offset:8
    s_mov_b64 exec, -1
    s_endpgm
K_att_slow:
    s_mov_b32 s25, 8388608
    s_mov_b32 s26, 64
    v_mov_b32 v86, 0xff800000
    v_subrev_u32 v4, s40, v3
    v_mov_b32 v3, v4
K_slow_max:
    buffer_load_dwordx4 v[140:143], v1, s[8:11], s25 offen sc1
    s_add_u32 s25, s25, 2048
    s_waitcnt vmcnt(0)
    v_mfma_f32_32x32x16_bf16 v[92:107], v[140:143], v[88:91], 0
    s_nop 15
    s_nop 0
    v_max3_f32 v86, v86, v92, v93
    v_max3_f32 v86, v86, v94, v95
    v_max3_f32 v86, v86, v96, v97
    v_max3_f32 v86, v86, v98, v99
    v_max3_f32 v86, v86, v100, v101
    v_max3_f32 v86, v86, v102, v103
    v_max3_f32 v86, v86, v104, v105
    v_max3_f32 v86, v86, v106, v107
    s_sub_u32 s26, s26, 1
    s_cmp_lg_u32 s26, 0
    s_cbranch_scc1 K_slow_max
    v_mov_b32 v85, v86
    s_nop 1
    v_permlane32_swap_b32 v86, v85
    s_nop 1
    v_max_f32 v86, v86, v85
    v_sub_f32 v12, 0, v86
    v_mov_b32 v60, 0
    v_sub_f32 v13, 0, v86
    v_mov_b32 v61, 0
    v_sub_f32 v14, 0, v86
    v_mov_b32 v62, 0
    v_sub_f32 v15, 0, v86
    v_mov_b32 v63, 0
    v_sub_f32 v16, 0, v86
    v_mov_b32 v64, 0
    v_sub_f32 v17, 0, v86
    v_mov_b32 v65, 0
    v_sub_f32 v18, 0, v86
    v_mov_b32 v66, 0
    v_sub_f32 v19, 0, v86
    v_mov_b32 v67, 0
    v_sub_f32 v20, 0, v86
    v_mov_b32 v68, 0
    v_sub_f32 v21, 0, v86
    v_mov_b32 v69, 0
    v_sub_f32 v22, 0, v86
    v_mov_b32 v70, 0
    v_sub_f32 v23, 0, v86
    v_mov_b32 v71, 0
    v_sub_f32 v24, 0, v86
    v_mov_b32 v72, 0
    v_sub_f32 v25, 0, v86
    v_mov_b32 v73, 0
    v_sub_f32 v26, 0, v86
    v_mov_b32 v74, 0
    v_sub_f32 v27, 0, v86
    v_mov_b32 v75, 0
    s_mov_b32 s25, 8388608
    s_mov_b32 s26, 64
K_slow_pv:
    buffer_load_dwordx4 v[140:143], v1, s[8:11], s25 offen sc1
    s_mov_b64 exec, s[42:43]
    buffer_load_dwordx4 v[124:127], v3, s[8:11], s25 offen offset:1024 sc1
    buffer_load_dwordx4 v[128:131], v4, s[8:11], s25 offen offset:1536 sc1
    s_mov_b64 exec, -1
    s_add_u32 s25, s25, 2048
    s_waitcnt vmcnt(0)
    v_mfma_f32_32x32x16_bf16 v[92:107], v[140:143], v[88:91], v[12:27]
    s_nop 15
    v_exp_f32 v92, v92
    v_exp_f32 v93, v93
    v_exp_f32 v94, v94
    v_exp_f32 v95, v95
    v_exp_f32 v96, v96
    v_exp_f32 v97, v97
    v_exp_f32 v98, v98
    v_exp_f32 v99, v99
    v_exp_f32 v100, v100
    v_exp_f32 v101, v101
    v_exp_f32 v102, v102
    v_exp_f32 v103, v103
    v_exp_f32 v104, v104
    v_exp_f32 v105, v105
    v_exp_f32 v106, v106
    v_exp_f32 v107, v107
    s_nop 1
    v_smfmac_f32_32x32x32_bf16 v[60:75], v[124:127], v[92:99], v5
    v_smfmac_f32_32x32x32_bf16 v[60:75], v[128:131], v[100:107], v5
    s_sub_u32 s26, s26, 1
    s_cmp_lg_u32 s26, 0
    s_cbranch_scc1 K_slow_pv
    s_nop 15
    s_branch K_att_fin
.p2align 6
K_gemm:
    v_mov_b32 v49, v1
    v_mov_b32 v2, 156160
    v_mov_b32 v144, 0
    v_mov_b32 v145, 0
    v_mov_b32 v146, 0
    v_mov_b32 v147, 0
    v_mov_b32 v148, 0
    v_mov_b32 v149, 0
    v_mov_b32 v150, 0
    v_mov_b32 v151, 0
    v_and_b32 v136, 3, v0
    v_and_b32 v137, 7, v0
    v_lshl_add_u32 v137, v137, 4, v2
    ds_write_b128 v137, v[144:147]
    s_load_dwordx4 s[12:15], s[0:1], 48
    s_load_dwordx4 s[40:43], s[0:1], 64
    s_load_dwordx2 s[44:45], s[0:1], 32
    s_load_dwordx2 s[52:53], s[0:1], 88
    v_lshlrev_b32 v57, 2, v53
    v_mov_b32 v51, 1088
    v_mad_u32_u24 v56, v53, v51, v54
    v_add_u32 v56, 147456, v56
    v_bfe_u32 v50, v0, 2, 2
    v_mul_u32_u24 v50, v50, v51
    v_lshrrev_b32 v51, 4, v0
    v_lshl_add_u32 v50, v51, 5, v50
    v_and_b32 v51, 3, v0
    v_lshl_add_u32 v50, v51, 3, v50
    v_lshl_add_u32 v50, v49, 8, v50
    v_add_u32 v50, 147456, v50
    v_lshrrev_b32 v51, 5, v0
    v_lshl_add_u32 v51, v49, 2, v51
    v_lshl_add_u32 v51, v51, 17, v54
    s_lshl_b32 s38, s73, 9
    s_add_u32 s39, s38, 262144
    s_lshl_b32 s32, s73, 5
    s_add_u32 s32, s32, 8650752
    v_mov_b32 v58, 0
    v_mov_b32 v59, 0
    v_mov_b32 v60, 0x3f803f80
    v_min_u32 v64, 7, v0
    v_lshlrev_b32 v64, 2, v64
    v_mov_b32 v66, 1
    s_lshl_b32 s3, s73, 5
    s_add_u32 s3, s3, 10092544
    s_waitcnt lgkmcnt(0)
    s_barrier
    s_waitcnt vmcnt(2)
    s_mov_b32 s6, 256
    s_mov_b32 s7, 0x20000
    s_or_b32 s73, s22, s20
    s_cbranch_scc1 K_nogate
    s_lshl_b32 s0, s2, 2
    s_waitcnt vmcnt(0)
    s_mov_b64 exec, 1
    buffer_store_dword v66, v64, s[4:7], s0 offen sc1
    s_mov_b64 exec, -1
K_nogate:
    v_dot2c_f32_bf16 v58, v16, v60
    v_dot2c_f32_bf16 v58, v17, v60
    v_dot2c_f32_bf16 v58, v18, v60
    v_dot2c_f32_bf16 v58, v19, v60
    v_dot2c_f32_bf16 v58, v20, v60
    v_dot2c_f32_bf16 v58, v21, v60
    v_dot2c_f32_bf16 v58, v22, v60
    v_dot2c_f32_bf16 v58, v23, v60
    v_lshlrev_b32 v32, 16, v16
    v_and_b32 v33, 0xffff0000, v16
    v_lshlrev_b32 v34, 16, v17
    v_and_b32 v35, 0xffff0000, v17
    v_lshlrev_b32 v36, 16, v18
    v_and_b32 v37, 0xffff0000, v18
    v_lshlrev_b32 v38, 16, v19
    v_and_b32 v39, 0xffff0000, v19
    v_lshlrev_b32 v40, 16, v20
    v_and_b32 v41, 0xffff0000, v20
    v_lshlrev_b32 v42, 16, v21
    v_and_b32 v43, 0xffff0000, v21
    v_lshlrev_b32 v44, 16, v22
    v_and_b32 v45, 0xffff0000, v22
    v_lshlrev_b32 v46, 16, v23
    v_and_b32 v47, 0xffff0000, v23
    v_add_f32_dpp v58, v58, v58 row_ror:8 row_mask:0xf bank_mask:0xf
    s_nop 1
    v_add_f32_dpp v58, v58, v58 row_ror:4 row_mask:0xf bank_mask:0xf
    s_nop 1
    v_add_f32_dpp v58, v58, v58 row_ror:2 row_mask:0xf bank_mask:0xf
    s_nop 1
    v_add_f32_dpp v58, v58, v58 row_ror:1 row_mask:0xf bank_mask:0xf
    s_nop 1
    v_mov_b32 v61, v58
    s_nop 1
    v_permlane16_swap_b32 v58, v61
    v_add_f32_e64 v58, v58, v61
    v_mul_f32 v62, 0xbb000000, v58
    v_pk_add_f32 v[32:33], v[32:33], v[62:63] op_sel_hi:[1,0]
    v_pk_add_f32 v[34:35], v[34:35], v[62:63] op_sel_hi:[1,0]
    v_pk_add_f32 v[36:37], v[36:37], v[62:63] op_sel_hi:[1,0]
    v_pk_add_f32 v[38:39], v[38:39], v[62:63] op_sel_hi:[1,0]
    v_pk_add_f32 v[40:41], v[40:41], v[62:63] op_sel_hi:[1,0]
    v_pk_add_f32 v[42:43], v[42:43], v[62:63] op_sel_hi:[1,0]
    v_pk_add_f32 v[44:45], v[44:45], v[62:63] op_sel_hi:[1,0]
    v_pk_add_f32 v[46:47], v[46:47], v[62:63] op_sel_hi:[1,0]
    v_pk_mul_f32 v[62:63], v[32:33], v[32:33]
    v_pk_fma_f32 v[62:63], v[34:35], v[34:35], v[62:63]
    v_pk_fma_f32 v[62:63], v[36:37], v[36:37], v[62:63]
    v_pk_fma_f32 v[62:63], v[38:39], v[38:39], v[62:63]
    v_pk_fma_f32 v[62:63], v[40:41], v[40:41], v[62:63]
    v_pk_fma_f32 v[62:63], v[42:43], v[42:43], v[62:63]
    v_pk_fma_f32 v[62:63], v[44:45], v[44:45], v[62:63]
    v_pk_fma_f32 v[62:63], v[46:47], v[46:47], v[62:63]
    s_cmp_eq_u32 s73, 0
    s_cbranch_scc1 K_nogw
    s_waitcnt vmcnt(0)
K_nogw:
    v_dot2c_f32_bf16 v59, v16, v24
    v_dot2c_f32_bf16 v59, v17, v25
    v_dot2c_f32_bf16 v59, v18, v26
    v_dot2c_f32_bf16 v59, v19, v27
    v_dot2c_f32_bf16 v59, v20, v28
    v_dot2c_f32_bf16 v59, v21, v29
    v_dot2c_f32_bf16 v59, v22, v30
    v_dot2c_f32_bf16 v59, v23, v31
    v_add_f32 v58, v62, v63
    s_nop 1
    v_add_f32_dpp v58, v58, v58 row_ror:8 row_mask:0xf bank_mask:0xf
    v_add_f32_dpp v59, v59, v59 row_ror:8 row_mask:0xf bank_mask:0xf
    s_nop 0
    v_add_f32_dpp v58, v58, v58 row_ror:4 row_mask:0xf bank_mask:0xf
    v_add_f32_dpp v59, v59, v59 row_ror:4 row_mask:0xf bank_mask:0xf
    s_nop 0
    v_add_f32_dpp v58, v58, v58 row_ror:2 row_mask:0xf bank_mask:0xf
    v_add_f32_dpp v59, v59, v59 row_ror:2 row_mask:0xf bank_mask:0xf
    s_nop 0
    v_add_f32_dpp v58, v58, v58 row_ror:1 row_mask:0xf bank_mask:0xf
    v_add_f32_dpp v59, v59, v59 row_ror:1 row_mask:0xf bank_mask:0xf
    s_nop 0
    v_mov_b32 v61, v58
    v_mov_b32 v62, v59
    s_nop 1
    v_permlane16_swap_b32 v58, v61
    v_permlane16_swap_b32 v59, v62
    v_add_f32 v58, v58, v61
    v_add_f32 v59, v59, v62
    v_mul_f32 v59, 0xbfb8aa3b, v59
    v_exp_f32 v59, v59
    v_mov_b32 v62, 0x3727c5ac
    v_fmac_f32 v62, 0x3b000000, v58
    v_rsq_f32 v62, v62
    v_add_f32 v59, 1.0, v59
    v_rcp_f32 v59, v59
    v_pk_mul_f32 v[32:33], v[32:33], v[62:63] op_sel_hi:[1,0]
    v_pk_mul_f32 v[34:35], v[34:35], v[62:63] op_sel_hi:[1,0]
    v_pk_mul_f32 v[36:37], v[36:37], v[62:63] op_sel_hi:[1,0]
    v_pk_mul_f32 v[38:39], v[38:39], v[62:63] op_sel_hi:[1,0]
    v_pk_mul_f32 v[40:41], v[40:41], v[62:63] op_sel_hi:[1,0]
    v_pk_mul_f32 v[42:43], v[42:43], v[62:63] op_sel_hi:[1,0]
    v_pk_mul_f32 v[44:45], v[44:45], v[62:63] op_sel_hi:[1,0]
    v_pk_mul_f32 v[46:47], v[46:47], v[62:63] op_sel_hi:[1,0]
    v_cvt_pk_bf16_f32 v16, v32, v33
    v_cvt_pk_bf16_f32 v17, v34, v35
    v_cvt_pk_bf16_f32 v18, v36, v37
    v_cvt_pk_bf16_f32 v19, v38, v39
    v_cvt_pk_bf16_f32 v20, v40, v41
    v_cvt_pk_bf16_f32 v21, v42, v43
    v_cvt_pk_bf16_f32 v22, v44, v45
    v_cvt_pk_bf16_f32 v23, v46, v47
    ds_write_b128 v56, v[16:19]
    ds_write_b128 v56, v[20:23] offset:512
    s_waitcnt lgkmcnt(0)
    s_mov_b64 exec, 1
    ds_add_u32 v2, v66 offset:72
    s_mov_b64 exec, -1
K_hst:
    ds_read_b32 v65, v2 offset:72
    s_waitcnt lgkmcnt(0)
    v_readfirstlane_b32 s73, v65
    s_cmp_ge_u32 s73, 4
    s_cbranch_scc1 K_hst_ok
    s_branch K_hst
K_hst_ok:
    ds_read_b64_tr_b16 v[32:33], v50
    ds_read_b64_tr_b16 v[34:35], v50 offset:4352
    ds_read_b64_tr_b16 v[36:37], v50 offset:128
    ds_read_b64_tr_b16 v[38:39], v50 offset:4480
    s_waitcnt lgkmcnt(2)
    buffer_store_dwordx4 v[32:35], v51, s[8:11], s38 offen sc1
    s_waitcnt lgkmcnt(0)
    buffer_store_dwordx4 v[36:39], v51, s[8:11], s39 offen sc1
    s_lshr_b32 s58, s20, 1
    s_and_b32 s59, s20, 1
    s_lshl_b32 s56, s21, 2
    s_lshr_b32 s33, s22, 3
    s_add_u32 s56, s56, s33
    s_and_b32 s57, s22, 7
    s_mul_i32 s33, s21, 28
    s_add_u32 s33, s33, s22
    s_and_b32 s30, s33, 7
    s_lshr_b32 s31, s33, 3
    s_mul_i32 s24, s20, 22528
    v_lshlrev_b32 v1, 4, v0
    v_lshrrev_b32 v138, 3, v0
    v_and_b32 v139, 7, v0
    v_bfe_u32 v140, v0, 4, 1
    v_lshlrev_b32 v140, 2, v140
    v_xor_b32 v139, v139, v140
    v_lshlrev_b32 v139, 4, v139
    v_mov_b32 v140, 3584
    v_mad_u32_u24 v4, v138, v140, v139
    v_add_u32 v5, 27648, v4
    v_mov_b32 v140, 4096
    v_mad_u32_u24 v6, v138, v140, v139
    v_add_u32 v7, 31744, v6
    v_mov_b32 v140, 1024
    v_mad_u32_u24 v8, v138, v140, v139
    v_add_u32 v9, 7168, v8
    s_xor_b32 s35, s31, s30
    s_and_b32 s35, s35, 3
    s_mul_i32 s34, s20, 229376
    s_lshl_b32 s33, s31, 7
    s_add_u32 s34, s34, s33
    s_lshr_b32 s36, s30, 2
    s_and_b32 s36, s36, 0
    s_xor_b32 s36, s36, s21
    s_xor_b32 s33, s21, 0
    s_mul_i32 s61, s33, 917504
    s_xor_b32 s33, s21, 1
    s_mul_i32 s62, s33, 917504
    s_xor_b32 s33, s36, 2
    s_mul_i32 s63, s33, 917504
    s_xor_b32 s33, s36, 3
    s_mul_i32 s64, s33, 917504
    s_xor_b32 s33, s36, 4
    s_mul_i32 s65, s33, 917504
    s_xor_b32 s33, s36, 5
    s_mul_i32 s66, s33, 917504
    s_xor_b32 s33, s36, 6
    s_mul_i32 s67, s33, 917504
    s_xor_b32 s33, s36, 7
    s_mul_i32 s68, s33, 917504
    s_xor_b32 s33, s35, 0
    s_mul_i32 s33, s33, 57344
    s_add_u32 s76, s33, s34
    s_xor_b32 s33, s35, 1
    s_mul_i32 s33, s33, 57344
    s_add_u32 s77, s33, s34
    s_xor_b32 s33, s35, 2
    s_mul_i32 s33, s33, 57344
    s_add_u32 s78, s33, s34
    s_xor_b32 s33, s35, 3
    s_mul_i32 s33, s33, 57344
    s_add_u32 s79, s33, s34
    s_lshl_b32 s27, s30, 1
    s_add_u32 s27, s27, s59
    s_mul_i32 s71, s27, 112
    s_lshl_b32 s27, s27, 3
    s_add_u32 s27, s27, s21
    s_lshl_b32 s27, s27, 2
    s_add_u32 s27, s27, s20
    s_lshl_b32 s27, s27, 2
    s_add_u32 s27, s27, s35
    s_lshl_b32 s27, s27, 10
    v_and_b32 v141, 31, v0
    v_lshlrev_b32 v142, 1, v141
    v_lshlrev_b32 v141, 2, v141
    s_lshl_b32 s36, s58, 6
    s_lshl_b32 s37, s31, 7
    s_add_u32 s37, s37, s36
    s_mov_b32 s16, s14
    s_mov_b32 s17, s15
    s_mov_b32 s48, s42
    s_mov_b32 s49, s43
    s_mov_b32 s14, 0x700000
    s_mov_b32 s15, 0x20000
    s_mov_b32 s18, 0xe00
    s_mov_b32 s19, 0x20000
    s_mov_b32 s42, 0x700000
    s_mov_b32 s43, 0x20000
    s_mov_b32 s46, 0x80000
    s_mov_b32 s47, 0x20000
    s_mov_b32 s50, 0x1000
    s_mov_b32 s51, 0x20000
    s_mov_b32 s54, 0x200000
    s_mov_b32 s55, 0x20000
    v_lshrrev_b32 v138, 5, v0
    v_lshlrev_b32 v10, 3, v138
    v_bfe_u32 v138, v0, 2, 2
    v_add_u32 v10, v10, v138
    v_lshlrev_b32 v10, 7, v10
    v_mov_b32 v65, 1
    s_cmp_lg_u32 s20, 0
    s_cbranch_scc1 K_nogl
    buffer_load_dword v65, v64, s[4:7], 0 offen sc1
K_nogl:
    v_bfe_u32 v138, v0, 4, 1
    v_lshl_add_u32 v10, v138, 5, v10
    v_and_b32 v138, 3, v0
    v_lshl_add_u32 v10, v138, 3, v10
    v_bfe_u32 v138, v0, 3, 1
    v_lshl_add_u32 v10, v138, 6, v10
    v_add_u32 v10, s24, v10
    v_xor_b32 v11, 64, v10
    v_xor_b32 v10, s36, v10
    v_xor_b32 v11, s36, v11
    v_lshrrev_b32 v138, 5, v0
    v_lshlrev_b32 v138, 9, v138
    v_sub_u32 v14, v10, v138
    v_sub_u32 v15, v11, v138
    s_xor_b32 s33, s58, s59
    s_lshl_b32 s33, s33, 6
    v_xor_b32 v12, s33, v14
    v_xor_b32 v13, s33, v15
    v_add_u32 v157, s24, v1
    v_lshrrev_b32 v138, 2, v0
    v_mov_b32 v139, 1088
    v_mul_u32_u24 v139, v136, v139
    v_lshl_add_u32 v139, v138, 4, v139
    v_lshlrev_b32 v159, 10, v138
    v_lshl_add_u32 v159, v136, 4, v159
    v_add_u32 v163, s24, v139
    v_mov_b32 v3, 1
    v_mov_b32 v158, 0xc0135761
    s_mov_b32 s74, 0xbdd2d3e8
    s_mov_b32 s75, 0xbdd2d3e8
    s_xor_b32 s33, s20, 1
    s_mul_i32 s33, s33, 22528
    v_add_u32 v160, s33, v1
    v_add_u32 v164, s33, v139
    s_xor_b32 s33, s20, 2
    s_mul_i32 s33, s33, 22528
    v_add_u32 v161, s33, v1
    v_add_u32 v165, s33, v139
    s_xor_b32 s33, s20, 3
    s_mul_i32 s33, s33, 22528
    v_add_u32 v162, s33, v1
    v_add_u32 v166, s33, v139
    s_lshl_b32 s33, s31, 2
    s_add_u32 s71, s71, s33
    s_lshl_b32 s33, s58, 1
    s_add_u32 s71, s71, s33
    s_lshl_b32 s71, s71, 10
    s_add_u32 s71, s71, 6291456
    s_mul_i32 s69, s20, 1835008
    s_lshl_b32 s33, s56, 7
    s_add_u32 s69, s69, s33
    s_lshl_b32 s70, s20, 17
    s_lshl_b32 s34, s57, 7
    s_add_u32 s70, s70, s34
    s_lshl_b32 s28, s57, 1
    s_add_u32 s28, s28, s58
    s_lshl_b32 s28, s28, 2
    s_add_u32 s28, s28, s20
    s_mul_i32 s28, s28, 28672
    s_add_u32 s28, s28, 6291456
    s_mul_i32 s33, s58, 229376
    s_sub_u32 s23, 114688, s33
    s_lshl_b32 s72, s56, 1
    s_add_u32 s72, s72, s59
    s_lshl_b32 s72, s72, 15
    s_lshl_b32 s33, s20, 13
    s_add_u32 s29, s72, s33
    s_add_u32 s29, s29, 4194304
    s_add_u32 s72, s72, s34
    s_add_u32 s72, s72, s36
    s_branch K_hgate_t
K_hgate:
    buffer_load_dword v65, v64, s[4:7], 0 offen sc1
K_hgate_t:
    s_waitcnt vmcnt(0)
    v_cmp_eq_u32 vcc, 0, v65
    s_cbranch_vccz K_hgate_ok
    s_cmp_eq_u32 s60, 0
    s_cbranch_scc1 K_hgate_ok
    s_sub_u32 s60, s60, 1
    s_mov_b64 exec, vcc
    s_sleep 2
    s_branch K_hgate
K_hgate_ok:
    s_mov_b64 exec, -1
    s_mov_b64 exec, 1
    ds_add_rtn_u32 v65, v2, v66 offset:24
    s_waitcnt lgkmcnt(0)
    v_readfirstlane_b32 s33, v65
    s_cmp_lg_u32 s33, 4
    s_cbranch_scc1 K_hf
    buffer_store_dword v66, v64, s[8:11], s3 offen offset:0 sc1
K_hf:
    s_mov_b64 exec, -1
    s_mov_b32 exec_lo, 1
    s_mov_b32 exec_hi, 1
    buffer_store_dword v59, v57, s[8:11], s32 offen sc1
    s_mov_b64 exec, -1
    buffer_load_ushort v143, v142, s[16:19], s37 offen
    s_lshl_b32 s33, s56, 7
    s_lshl_b32 s34, s59, 6
    s_add_u32 s33, s33, s34
    buffer_load_ushort v156, v142, s[48:51], s33 offen
    v_lshrrev_b32 v155, 3, v0
    v_lshlrev_b32 v155, 5, v155
    s_lshl_b32 s73, s21, 2
    s_add_u32 s73, s73, s20
    s_lshl_b32 s73, s73, 8
    s_add_u32 s73, s73, 10092544
    v_cmp_gt_u32 vcc, 32, v0
    v_mov_b32 v138, 0x3f80
    s_waitcnt vmcnt(0)
    v_cndmask_b32 v144, 0, v143, vcc
    v_cndmask_b32 v148, 0, v138, vcc
    s_nop 1
    v_mfma_f32_32x32x16_bf16 v[32:47], v[144:147], v[148:151], 0
    s_setprio 3
K_own:
    ds_read_b32 v64, v2 offset:24
    s_waitcnt lgkmcnt(0)
    v_readfirstlane_b32 s33, v64
    s_cmp_ge_u32 s33, 5
    s_cbranch_scc1 K_own_ok
    s_sleep 1
    s_branch K_own
K_own_ok:
    v_lshrrev_b32 v167, 2, v0
    v_mov_b32 v153, 3584
    v_mul_u32_u24 v167, v167, v153
    v_lshl_add_u32 v167, v136, 7, v167
    s_mul_i32 s34, s21, 28
    s_add_u32 s35, s34, s22
    s_add_u32 s34, s34, 28
    s_and_b32 s33, s34, 31
    s_max_u32 s33, s33, 24
    s_lshr_b32 s34, s34, 5
    s_lshl_b32 s34, s34, 3
    s_add_u32 s34, s34, s33
    s_and_b32 s33, s35, 31
    s_max_u32 s33, s33, 24
    s_lshr_b32 s35, s35, 5
    s_lshl_b32 s35, s35, 3
    s_add_u32 s35, s35, s33
    s_sub_u32 s34, s34, s35
    s_add_u32 s32, s22, s34
    s_and_b32 s33, s31, 3
    s_cmp_eq_u32 s33, 3
    s_cselect_b32 s32, 99, s32
    s_add_u32 s35, s32, 4
    s_and_b32 s35, s35, 31
    s_lshr_b32 s33, s35, 2
    s_xor_b32 s33, s33, s21
    s_lshl_b32 s33, s33, 2
    s_add_u32 s33, s33, s20
    s_lshl_b32 s33, s33, 2
    s_and_b32 s34, s35, 3
    s_add_u32 s33, s33, s34
    s_mul_i32 s33, s33, 57344
    s_mul_i32 s34, s21, 7
    s_lshr_b32 s34, s34, 1
    s_lshl_b32 s34, s34, 7
    s_add_u32 s3, s33, s34
K_gl:
    ds_read_b64 v[64:65], v2 offset:64
    s_waitcnt lgkmcnt(0)
    v_min_u32 v64, v64, v65
    s_nop 0
    v_readfirstlane_b32 s33, v64
    s_cmp_ge_u32 s33, 7
    s_cbranch_scc1 K_gl_ok
    s_sleep 1
    s_branch K_gl
K_gl_ok:
K_hpoll:
    buffer_load_dword v153, v155, s[8:11], s73 offen sc1
K_hpoll_t:
    s_waitcnt vmcnt(0)
    v_cmp_eq_u32 vcc, 0, v153
    s_cbranch_vccz K_hpoll_ok
    s_cmp_eq_u32 s60, 0
    s_cbranch_scc1 K_hpoll_ok
    s_sub_u32 s60, s60, 1
    s_mov_b64 exec, vcc
    s_sleep 2
    s_branch K_hpoll
K_hpoll_ok:
    s_mov_b64 exec, -1
    s_barrier
    s_barrier
    s_setprio 0
    s_cmp_ge_u32 s22, 28
    s_cbranch_scc1 K_no_up
    s_add_u32 m0, s24, 0
    s_add_u32 s26, s61, s76
    buffer_load_dwordx4 v4, s[12:15], s26 offen lds
    buffer_load_dwordx4 v5, s[12:15], s26 offen offset:1024 lds
    s_xor_b32 s25, s27, 0
    buffer_load_dwordx4 v[96:99], v1, s[8:11], s25 offen sc1
    s_xor_b32 s25, s25, 131072
    buffer_load_dwordx4 v[100:103], v1, s[8:11], s25 offen sc1
    s_add_u32 m0, s24, 2048
    s_add_u32 s26, s61, s77
    buffer_load_dwordx4 v4, s[12:15], s26 offen lds
    buffer_load_dwordx4 v5, s[12:15], s26 offen offset:1024 lds
    s_xor_b32 s25, s27, 1024
    buffer_load_dwordx4 v[104:107], v1, s[8:11], s25 offen sc1
    s_xor_b32 s25, s25, 131072
    buffer_load_dwordx4 v[108:111], v1, s[8:11], s25 offen sc1
    s_add_u32 m0, s24, 4096
    s_add_u32 s26, s61, s78
    buffer_load_dwordx4 v4, s[12:15], s26 offen lds
    buffer_load_dwordx4 v5, s[12:15], s26 offen offset:1024 lds
    s_xor_b32 s25, s27, 2048
    buffer_load_dwordx4 v[112:115], v1, s[8:11], s25 offen sc1
    s_xor_b32 s25, s25, 131072
    buffer_load_dwordx4 v[116:119], v1, s[8:11], s25 offen sc1
    s_add_u32 m0, s24, 6144
    s_add_u32 s26, s61, s79
    buffer_load_dwordx4 v4, s[12:15], s26 offen lds
    buffer_load_dwordx4 v5, s[12:15], s26 offen offset:1024 lds
    s_xor_b32 s25, s27, 3072
    buffer_load_dwordx4 v[120:123], v1, s[8:11], s25 offen sc1
    s_xor_b32 s25, s25, 131072
    buffer_load_dwordx4 v[124:127], v1, s[8:11], s25 offen sc1
    s_add_u32 m0, s24, 8192
    s_add_u32 s26, s62, s76
    buffer_load_dwordx4 v4, s[12:15], s26 offen lds
    buffer_load_dwordx4 v5, s[12:15], s26 offen offset:1024 lds
    s_waitcnt vmcnt(16)
    ds_read_b64_tr_b16 v[16:17], v10 offset:0
    ds_read_b64_tr_b16 v[18:19], v10 offset:512
    ds_read_b64_tr_b16 v[20:21], v11 offset:0
    ds_read_b64_tr_b16 v[22:23], v11 offset:512
    s_waitcnt vmcnt(12)
    s_waitcnt lgkmcnt(0)
    v_mfma_f32_32x32x16_bf16 v[32:47], v[16:19], v[96:99], v[32:47]
    ds_read_b64_tr_b16 v[24:25], v10 offset:2048
    ds_read_b64_tr_b16 v[26:27], v10 offset:2560
    s_add_u32 m0, s24, 0
    s_add_u32 s26, s62, s77
    buffer_load_dwordx4 v4, s[12:15], s26 offen lds
    buffer_load_dwordx4 v5, s[12:15], s26 offen offset:1024 lds
    v_mfma_f32_32x32x16_bf16 v[48:63], v[16:19], v[100:103], 0
    ds_read_b64_tr_b16 v[28:29], v11 offset:2048
    ds_read_b64_tr_b16 v[30:31], v11 offset:2560
    s_setprio 3
    s_lshl_b32 s33, s20, 2
    v_add_u32 v155, s33, v2
K_wspin:
    ds_read_b32 v153, v155 offset:32
    s_waitcnt lgkmcnt(0)
    v_readfirstlane_b32 s33, v153
    s_cmp_ge_u32 s33, 2
    s_cbranch_scc1 K_wspin_ok
    s_sleep 1
    s_branch K_wspin
K_wspin_ok:
    s_setprio 0
    s_nop 0
    s_xor_b32 s25, s27, 16384
    buffer_load_dwordx4 v[128:131], v1, s[8:11], s25 offen sc1
    s_xor_b32 s25, s25, 131072
    buffer_load_dwordx4 v[132:135], v1, s[8:11], s25 offen sc1
    v_mfma_f32_32x32x16_bf16 v[64:79], v[20:23], v[96:99], 0
    s_xor_b32 s25, s27, 17408
    buffer_load_dwordx4 v[136:139], v1, s[8:11], s25 offen sc1
    v_mfma_f32_32x32x16_bf16 v[80:95], v[20:23], v[100:103], 0
    s_xor_b32 s25, s25, 131072
    buffer_load_dwordx4 v[140:143], v1, s[8:11], s25 offen sc1
    s_waitcnt vmcnt(14)
    s_waitcnt lgkmcnt(0)
    v_mfma_f32_32x32x16_bf16 v[32:47], v[24:27], v[104:107], v[32:47]
    ds_read_b64_tr_b16 v[16:17], v10 offset:4096
    ds_read_b64_tr_b16 v[18:19], v10 offset:4608
    s_add_u32 m0, s24, 2048
    s_add_u32 s26, s62, s78
    s_nop 0
    buffer_load_dwordx4 v4, s[12:15], s26 offen lds
    v_mfma_f32_32x32x16_bf16 v[48:63], v[24:27], v[108:111], v[48:63]
    ds_read_b64_tr_b16 v[20:21], v11 offset:4096
    ds_read_b64_tr_b16 v[22:23], v11 offset:4608
    buffer_load_dwordx4 v5, s[12:15], s26 offen offset:1024 lds
    v_mfma_f32_32x32x16_bf16 v[64:79], v[28:31], v[104:107], v[64:79]
    s_xor_b32 s25, s27, 18432
    buffer_load_dwordx4 v[144:147], v1, s[8:11], s25 offen sc1
    v_mfma_f32_32x32x16_bf16 v[80:95], v[28:31], v[108:111], v[80:95]
    s_xor_b32 s25, s25, 131072
    buffer_load_dwordx4 v[148:151], v1, s[8:11], s25 offen sc1
    s_waitcnt vmcnt(14)
    s_waitcnt lgkmcnt(0)
    s_cmp_eq_u32 s32, 8
    s_cbranch_scc1 K_jit2
K_jitr2:
    v_mfma_f32_32x32x16_bf16 v[32:47], v[16:19], v[112:115], v[32:47]
    ds_read_b64_tr_b16 v[24:25], v10 offset:6144
    ds_read_b64_tr_b16 v[26:27], v10 offset:6656
    s_add_u32 m0, s24, 4096
    s_add_u32 s26, s62, s79
    s_nop 0
    buffer_load_dwordx4 v4, s[12:15], s26 offen lds
    v_mfma_f32_32x32x16_bf16 v[48:63], v[16:19], v[116:119], v[48:63]
    ds_read_b64_tr_b16 v[28:29], v11 offset:6144
    ds_read_b64_tr_b16 v[30:31], v11 offset:6656
    buffer_load_dwordx4 v5, s[12:15], s26 offen offset:1024 lds
    v_mfma_f32_32x32x16_bf16 v[64:79], v[20:23], v[112:115], v[64:79]
    s_xor_b32 s25, s27, 19456
    buffer_load_dwordx4 v[96:99], v1, s[8:11], s25 offen sc1
    v_mfma_f32_32x32x16_bf16 v[80:95], v[20:23], v[116:119], v[80:95]
    s_xor_b32 s25, s25, 131072
    buffer_load_dwordx4 v[100:103], v1, s[8:11], s25 offen sc1
    s_waitcnt vmcnt(14)
    s_waitcnt lgkmcnt(0)
    s_cmp_eq_u32 s32, 9
    s_cbranch_scc1 K_jit3
K_jitr3:
    v_mfma_f32_32x32x16_bf16 v[32:47], v[24:27], v[120:123], v[32:47]
    ds_read_b64_tr_b16 v[16:17], v10 offset:8192
    ds_read_b64_tr_b16 v[18:19], v10 offset:8704
    s_add_u32 m0, s24, 6144
    s_add_u32 s26, s63, s76
    s_nop 0
    buffer_load_dwordx4 v4, s[12:15], s26 offen lds
    v_mfma_f32_32x32x16_bf16 v[48:63], v[24:27], v[124:127], v[48:63]
    ds_read_b64_tr_b16 v[20:21], v11 offset:8192
    ds_read_b64_tr_b16 v[22:23], v11 offset:8704
    buffer_load_dwordx4 v5, s[12:15], s26 offen offset:1024 lds
    v_mfma_f32_32x32x16_bf16 v[64:79], v[28:31], v[120:123], v[64:79]
    s_xor_b32 s25, s27, 32768
    buffer_load_dwordx4 v[104:107], v1, s[8:11], s25 offen sc1
    v_mfma_f32_32x32x16_bf16 v[80:95], v[28:31], v[124:127], v[80:95]
    s_xor_b32 s25, s25, 131072
    buffer_load_dwordx4 v[108:111], v1, s[8:11], s25 offen sc1
    s_waitcnt vmcnt(14)
    s_waitcnt lgkmcnt(0)
    s_cmp_eq_u32 s32, 10
    s_cbranch_scc1 K_jit4
K_jitr4:
    v_mfma_f32_32x32x16_bf16 v[32:47], v[16:19], v[128:131], v[32:47]
    ds_read_b64_tr_b16 v[24:25], v10 offset:0
    ds_read_b64_tr_b16 v[26:27], v10 offset:512
    s_add_u32 m0, s24, 8192
    s_add_u32 s26, s63, s77
    s_nop 0
    buffer_load_dwordx4 v4, s[12:15], s26 offen lds
    v_mfma_f32_32x32x16_bf16 v[48:63], v[16:19], v[132:135], v[48:63]
    ds_read_b64_tr_b16 v[28:29], v11 offset:0
    ds_read_b64_tr_b16 v[30:31], v11 offset:512
    buffer_load_dwordx4 v5, s[12:15], s26 offen offset:1024 lds
    v_mfma_f32_32x32x16_bf16 v[64:79], v[20:23], v[128:131], v[64:79]
    s_xor_b32 s25, s27, 33792
    buffer_load_dwordx4 v[112:115], v1, s[8:11], s25 offen sc1
    v_mfma_f32_32x32x16_bf16 v[80:95], v[20:23], v[132:135], v[80:95]
    s_xor_b32 s25, s25, 131072
    buffer_load_dwordx4 v[116:119], v1, s[8:11], s25 offen sc1
    s_waitcnt vmcnt(14)
    s_waitcnt lgkmcnt(0)
    s_cmp_eq_u32 s32, 11
    s_cbranch_scc1 K_jit5
K_jitr5:
    v_mfma_f32_32x32x16_bf16 v[32:47], v[24:27], v[136:139], v[32:47]
    ds_read_b64_tr_b16 v[16:17], v10 offset:2048
    ds_read_b64_tr_b16 v[18:19], v10 offset:2560
    s_add_u32 m0, s24, 0
    s_add_u32 s26, s63, s78
    buffer_load_dwordx4 v4, s[12:15], s26 offen lds
    v_mfma_f32_32x32x16_bf16 v[48:63], v[24:27], v[140:143], v[48:63]
    ds_read_b64_tr_b16 v[20:21], v11 offset:2048
    ds_read_b64_tr_b16 v[22:23], v11 offset:2560
    buffer_load_dwordx4 v5, s[12:15], s26 offen offset:1024 lds
    v_mfma_f32_32x32x16_bf16 v[64:79], v[28:31], v[136:139], v[64:79]
    s_xor_b32 s25, s27, 34816
    buffer_load_dwordx4 v[120:123], v1, s[8:11], s25 offen sc1
    v_mfma_f32_32x32x16_bf16 v[80:95], v[28:31], v[140:143], v[80:95]
    s_xor_b32 s25, s25, 131072
    buffer_load_dwordx4 v[124:127], v1, s[8:11], s25 offen sc1
    s_waitcnt vmcnt(14)
    s_waitcnt lgkmcnt(0)
    s_cmp_eq_u32 s32, 12
    s_cbranch_scc1 K_jit6
K_jitr6:
    v_mfma_f32_32x32x16_bf16 v[32:47], v[16:19], v[144:147], v[32:47]
    ds_read_b64_tr_b16 v[24:25], v10 offset:4096
    ds_read_b64_tr_b16 v[26:27], v10 offset:4608
    s_add_u32 m0, s24, 2048
    s_add_u32 s26, s63, s79
    s_nop 0
    buffer_load_dwordx4 v4, s[12:15], s26 offen lds
    v_mfma_f32_32x32x16_bf16 v[48:63], v[16:19], v[148:151], v[48:63]
    ds_read_b64_tr_b16 v[28:29], v11 offset:4096
    ds_read_b64_tr_b16 v[30:31], v11 offset:4608
    buffer_load_dwordx4 v5, s[12:15], s26 offen offset:1024 lds
    v_mfma_f32_32x32x16_bf16 v[64:79], v[20:23], v[144:147], v[64:79]
    s_xor_b32 s25, s27, 35840
    buffer_load_dwordx4 v[128:131], v1, s[8:11], s25 offen sc1
    v_mfma_f32_32x32x16_bf16 v[80:95], v[20:23], v[148:151], v[80:95]
    s_xor_b32 s25, s25, 131072
    buffer_load_dwordx4 v[132:135], v1, s[8:11], s25 offen sc1
    s_waitcnt vmcnt(14)
    s_waitcnt lgkmcnt(0)
    s_cmp_eq_u32 s32, 13
    s_cbranch_scc1 K_jit7
K_jitr7:
    v_mfma_f32_32x32x16_bf16 v[32:47], v[24:27], v[96:99], v[32:47]
    ds_read_b64_tr_b16 v[16:17], v10 offset:6144
    ds_read_b64_tr_b16 v[18:19], v10 offset:6656
    s_add_u32 m0, s24, 4096
    s_add_u32 s26, s64, s76
    s_nop 0
    buffer_load_dwordx4 v4, s[12:15], s26 offen lds
    v_mfma_f32_32x32x16_bf16 v[48:63], v[24:27], v[100:103], v[48:63]
    ds_read_b64_tr_b16 v[20:21], v11 offset:6144
    ds_read_b64_tr_b16 v[22:23], v11 offset:6656
    buffer_load_dwordx4 v5, s[12:15], s26 offen offset:1024 lds
    v_mfma_f32_32x32x16_bf16 v[64:79], v[28:31], v[96:99], v[64:79]
    s_xor_b32 s25, s27, 49152
    buffer_load_dwordx4 v[136:139], v1, s[8:11], s25 offen sc1
    v_mfma_f32_32x32x16_bf16 v[80:95], v[28:31], v[100:103], v[80:95]
    s_xor_b32 s25, s25, 131072
    buffer_load_dwordx4 v[140:143], v1, s[8:11], s25 offen sc1
    s_waitcnt vmcnt(14)
    s_waitcnt lgkmcnt(0)
    s_cmp_eq_u32 s32, 14
    s_cbranch_scc1 K_jit8
K_jitr8:
    v_mfma_f32_32x32x16_bf16 v[32:47], v[16:19], v[104:107], v[32:47]
    ds_read_b64_tr_b16 v[24:25], v10 offset:8192
    ds_read_b64_tr_b16 v[26:27], v10 offset:8704
    s_add_u32 m0, s24, 6144
    s_add_u32 s26, s64, s77
    s_nop 0
    buffer_load_dwordx4 v4, s[12:15], s26 offen lds
    v_mfma_f32_32x32x16_bf16 v[48:63], v[16:19], v[108:111], v[48:63]
    ds_read_b64_tr_b16 v[28:29], v11 offset:8192
    ds_read_b64_tr_b16 v[30:31], v11 offset:8704
    buffer_load_dwordx4 v5, s[12:15], s26 offen offset:1024 lds
    v_mfma_f32_32x32x16_bf16 v[64:79], v[20:23], v[104:107], v[64:79]
    s_xor_b32 s25, s27, 50176
    buffer_load_dwordx4 v[144:147], v1, s[8:11], s25 offen sc1
    v_mfma_f32_32x32x16_bf16 v[80:95], v[20:23], v[108:111], v[80:95]
    s_xor_b32 s25, s25, 131072
    buffer_load_dwordx4 v[148:151], v1, s[8:11], s25 offen sc1
    s_waitcnt vmcnt(14)
    s_waitcnt lgkmcnt(0)
    s_cmp_eq_u32 s32, 15
    s_cbranch_scc1 K_jit9
K_jitr9:
    v_mfma_f32_32x32x16_bf16 v[32:47], v[24:27], v[112:115], v[32:47]
    ds_read_b64_tr_b16 v[16:17], v10 offset:0
    ds_read_b64_tr_b16 v[18:19], v10 offset:512
    s_add_u32 m0, s24, 8192
    s_add_u32 s26, s64, s78
    s_nop 0
    buffer_load_dwordx4 v4, s[12:15], s26 offen lds
    v_mfma_f32_32x32x16_bf16 v[48:63], v[24:27], v[116:119], v[48:63]
    ds_read_b64_tr_b16 v[20:21], v11 offset:0
    ds_read_b64_tr_b16 v[22:23], v11 offset:512
    buffer_load_dwordx4 v5, s[12:15], s26 offen offset:1024 lds
    v_mfma_f32_32x32x16_bf16 v[64:79], v[28:31], v[112:115], v[64:79]
    s_xor_b32 s25, s27, 51200
    buffer_load_dwordx4 v[96:99], v1, s[8:11], s25 offen sc1
    v_mfma_f32_32x32x16_bf16 v[80:95], v[28:31], v[116:119], v[80:95]
    s_xor_b32 s25, s25, 131072
    buffer_load_dwordx4 v[100:103], v1, s[8:11], s25 offen sc1
    s_waitcnt vmcnt(14)
    s_waitcnt lgkmcnt(0)
    s_cmp_eq_u32 s32, 16
    s_cbranch_scc1 K_jit10
K_jitr10:
    v_mfma_f32_32x32x16_bf16 v[32:47], v[16:19], v[120:123], v[32:47]
    ds_read_b64_tr_b16 v[24:25], v10 offset:2048
    ds_read_b64_tr_b16 v[26:27], v10 offset:2560
    s_add_u32 m0, s24, 0
    s_add_u32 s26, s64, s79
    buffer_load_dwordx4 v4, s[12:15], s26 offen lds
    v_mfma_f32_32x32x16_bf16 v[48:63], v[16:19], v[124:127], v[48:63]
    ds_read_b64_tr_b16 v[28:29], v11 offset:2048
    ds_read_b64_tr_b16 v[30:31], v11 offset:2560
    buffer_load_dwordx4 v5, s[12:15], s26 offen offset:1024 lds
    v_mfma_f32_32x32x16_bf16 v[64:79], v[20:23], v[120:123], v[64:79]
    s_xor_b32 s25, s27, 52224
    buffer_load_dwordx4 v[104:107], v1, s[8:11], s25 offen sc1
    v_mfma_f32_32x32x16_bf16 v[80:95], v[20:23], v[124:127], v[80:95]
    s_xor_b32 s25, s25, 131072
    buffer_load_dwordx4 v[108:111], v1, s[8:11], s25 offen sc1
    s_waitcnt vmcnt(14)
    s_waitcnt lgkmcnt(0)
    s_cmp_eq_u32 s32, 17
    s_cbranch_scc1 K_jit11
K_jitr11:
    v_mfma_f32_32x32x16_bf16 v[32:47], v[24:27], v[128:131], v[32:47]
    ds_read_b64_tr_b16 v[16:17], v10 offset:4096
    ds_read_b64_tr_b16 v[18:19], v10 offset:4608
    s_add_u32 m0, s24, 2048
    s_add_u32 s26, s65, s76
    s_nop 0
    buffer_load_dwordx4 v4, s[12:15], s26 offen lds
    v_mfma_f32_32x32x16_bf16 v[48:63], v[24:27], v[132:135], v[48:63]
    ds_read_b64_tr_b16 v[20:21], v11 offset:4096
    ds_read_b64_tr_b16 v[22:23], v11 offset:4608
    buffer_load_dwordx4 v5, s[12:15], s26 offen offset:1024 lds
    v_mfma_f32_32x32x16_bf16 v[64:79], v[28:31], v[128:131], v[64:79]
    s_xor_b32 s25, s27, 65536
    buffer_load_dwordx4 v[112:115], v1, s[8:11], s25 offen sc1
    v_mfma_f32_32x32x16_bf16 v[80:95], v[28:31], v[132:135], v[80:95]
    s_xor_b32 s25, s25, 131072
    buffer_load_dwordx4 v[116:119], v1, s[8:11], s25 offen sc1
    s_waitcnt vmcnt(14)
    s_waitcnt lgkmcnt(0)
    s_cmp_eq_u32 s32, 18
    s_cbranch_scc1 K_jit12
K_jitr12:
    v_mfma_f32_32x32x16_bf16 v[32:47], v[16:19], v[136:139], v[32:47]
    ds_read_b64_tr_b16 v[24:25], v10 offset:6144
    ds_read_b64_tr_b16 v[26:27], v10 offset:6656
    s_add_u32 m0, s24, 4096
    s_add_u32 s26, s65, s77
    s_nop 0
    buffer_load_dwordx4 v4, s[12:15], s26 offen lds
    v_mfma_f32_32x32x16_bf16 v[48:63], v[16:19], v[140:143], v[48:63]
    ds_read_b64_tr_b16 v[28:29], v11 offset:6144
    ds_read_b64_tr_b16 v[30:31], v11 offset:6656
    buffer_load_dwordx4 v5, s[12:15], s26 offen offset:1024 lds
    v_mfma_f32_32x32x16_bf16 v[64:79], v[20:23], v[136:139], v[64:79]
    s_xor_b32 s25, s27, 66560
    buffer_load_dwordx4 v[120:123], v1, s[8:11], s25 offen sc1
    v_mfma_f32_32x32x16_bf16 v[80:95], v[20:23], v[140:143], v[80:95]
    s_xor_b32 s25, s25, 131072
    buffer_load_dwordx4 v[124:127], v1, s[8:11], s25 offen sc1
    s_waitcnt vmcnt(14)
    s_waitcnt lgkmcnt(0)
    s_cmp_eq_u32 s32, 19
    s_cbranch_scc1 K_jit13
K_jitr13:
    v_mfma_f32_32x32x16_bf16 v[32:47], v[24:27], v[144:147], v[32:47]
    ds_read_b64_tr_b16 v[16:17], v10 offset:8192
    ds_read_b64_tr_b16 v[18:19], v10 offset:8704
    s_add_u32 m0, s24, 6144
    s_add_u32 s26, s65, s78
    s_nop 0
    buffer_load_dwordx4 v4, s[12:15], s26 offen lds
    v_mfma_f32_32x32x16_bf16 v[48:63], v[24:27], v[148:151], v[48:63]
    ds_read_b64_tr_b16 v[20:21], v11 offset:8192
    ds_read_b64_tr_b16 v[22:23], v11 offset:8704
    buffer_load_dwordx4 v5, s[12:15], s26 offen offset:1024 lds
    v_mfma_f32_32x32x16_bf16 v[64:79], v[28:31], v[144:147], v[64:79]
    s_xor_b32 s25, s27, 67584
    buffer_load_dwordx4 v[128:131], v1, s[8:11], s25 offen sc1
    v_mfma_f32_32x32x16_bf16 v[80:95], v[28:31], v[148:151], v[80:95]
    s_xor_b32 s25, s25, 131072
    buffer_load_dwordx4 v[132:135], v1, s[8:11], s25 offen sc1
    s_waitcnt vmcnt(14)
    s_waitcnt lgkmcnt(0)
    s_cmp_eq_u32 s32, 20
    s_cbranch_scc1 K_jit14
K_jitr14:
    v_mfma_f32_32x32x16_bf16 v[32:47], v[16:19], v[96:99], v[32:47]
    ds_read_b64_tr_b16 v[24:25], v10 offset:0
    ds_read_b64_tr_b16 v[26:27], v10 offset:512
    s_add_u32 m0, s24, 8192
    s_add_u32 s26, s65, s79
    s_nop 0
    buffer_load_dwordx4 v4, s[12:15], s26 offen lds
    v_mfma_f32_32x32x16_bf16 v[48:63], v[16:19], v[100:103], v[48:63]
    ds_read_b64_tr_b16 v[28:29], v11 offset:0
    ds_read_b64_tr_b16 v[30:31], v11 offset:512
    buffer_load_dwordx4 v5, s[12:15], s26 offen offset:1024 lds
    v_mfma_f32_32x32x16_bf16 v[64:79], v[20:23], v[96:99], v[64:79]
    s_xor_b32 s25, s27, 68608
    buffer_load_dwordx4 v[136:139], v1, s[8:11], s25 offen sc1
    v_mfma_f32_32x32x16_bf16 v[80:95], v[20:23], v[100:103], v[80:95]
    s_xor_b32 s25, s25, 131072
    buffer_load_dwordx4 v[140:143], v1, s[8:11], s25 offen sc1
    s_waitcnt vmcnt(14)
    s_waitcnt lgkmcnt(0)
    s_cmp_eq_u32 s32, 21
    s_cbranch_scc1 K_jit15
K_jitr15:
    v_mfma_f32_32x32x16_bf16 v[32:47], v[24:27], v[104:107], v[32:47]
    ds_read_b64_tr_b16 v[16:17], v10 offset:2048
    ds_read_b64_tr_b16 v[18:19], v10 offset:2560
    s_add_u32 m0, s24, 0
    s_add_u32 s26, s66, s76
    buffer_load_dwordx4 v4, s[12:15], s26 offen lds
    v_mfma_f32_32x32x16_bf16 v[48:63], v[24:27], v[108:111], v[48:63]
    ds_read_b64_tr_b16 v[20:21], v11 offset:2048
    ds_read_b64_tr_b16 v[22:23], v11 offset:2560
    buffer_load_dwordx4 v5, s[12:15], s26 offen offset:1024 lds
    v_mfma_f32_32x32x16_bf16 v[64:79], v[28:31], v[104:107], v[64:79]
    s_xor_b32 s25, s27, 81920
    buffer_load_dwordx4 v[144:147], v1, s[8:11], s25 offen sc1
    v_mfma_f32_32x32x16_bf16 v[80:95], v[28:31], v[108:111], v[80:95]
    s_xor_b32 s25, s25, 131072
    buffer_load_dwordx4 v[148:151], v1, s[8:11], s25 offen sc1
    s_waitcnt vmcnt(14)
    s_waitcnt lgkmcnt(0)
    s_cmp_eq_u32 s32, 22
    s_cbranch_scc1 K_jit16
K_jitr16:
    v_mfma_f32_32x32x16_bf16 v[32:47], v[16:19], v[112:115], v[32:47]
    ds_read_b64_tr_b16 v[24:25], v10 offset:4096
    ds_read_b64_tr_b16 v[26:27], v10 offset:4608
    s_add_u32 m0, s24, 2048
    s_add_u32 s26, s66, s77
    s_nop 0
    buffer_load_dwordx4 v4, s[12:15], s26 offen lds
    v_mfma_f32_32x32x16_bf16 v[48:63], v[16:19], v[116:119], v[48:63]
    ds_read_b64_tr_b16 v[28:29], v11 offset:4096
    ds_read_b64_tr_b16 v[30:31], v11 offset:4608
    buffer_load_dwordx4 v5, s[12:15], s26 offen offset:1024 lds
    v_mfma_f32_32x32x16_bf16 v[64:79], v[20:23], v[112:115], v[64:79]
    s_xor_b32 s25, s27, 82944
    buffer_load_dwordx4 v[96:99], v1, s[8:11], s25 offen sc1
    v_mfma_f32_32x32x16_bf16 v[80:95], v[20:23], v[116:119], v[80:95]
    s_xor_b32 s25, s25, 131072
    buffer_load_dwordx4 v[100:103], v1, s[8:11], s25 offen sc1
    s_waitcnt vmcnt(14)
    s_waitcnt lgkmcnt(0)
    s_cmp_eq_u32 s32, 23
    s_cbranch_scc1 K_jit17
K_jitr17:
    v_mfma_f32_32x32x16_bf16 v[32:47], v[24:27], v[120:123], v[32:47]
    ds_read_b64_tr_b16 v[16:17], v10 offset:6144
    ds_read_b64_tr_b16 v[18:19], v10 offset:6656
    s_add_u32 m0, s24, 4096
    s_add_u32 s26, s66, s78
    s_nop 0
    buffer_load_dwordx4 v4, s[12:15], s26 offen lds
    v_mfma_f32_32x32x16_bf16 v[48:63], v[24:27], v[124:127], v[48:63]
    ds_read_b64_tr_b16 v[20:21], v11 offset:6144
    ds_read_b64_tr_b16 v[22:23], v11 offset:6656
    buffer_load_dwordx4 v5, s[12:15], s26 offen offset:1024 lds
    v_mfma_f32_32x32x16_bf16 v[64:79], v[28:31], v[120:123], v[64:79]
    s_xor_b32 s25, s27, 83968
    buffer_load_dwordx4 v[104:107], v1, s[8:11], s25 offen sc1
    v_mfma_f32_32x32x16_bf16 v[80:95], v[28:31], v[124:127], v[80:95]
    s_xor_b32 s25, s25, 131072
    buffer_load_dwordx4 v[108:111], v1, s[8:11], s25 offen sc1
    s_waitcnt vmcnt(14)
    s_waitcnt lgkmcnt(0)
    s_cmp_eq_u32 s32, 24
    s_cbranch_scc1 K_jit18
K_jitr18:
    v_mfma_f32_32x32x16_bf16 v[32:47], v[16:19], v[128:131], v[32:47]
    ds_read_b64_tr_b16 v[24:25], v10 offset:8192
    ds_read_b64_tr_b16 v[26:27], v10 offset:8704
    s_add_u32 m0, s24, 6144
    s_add_u32 s26, s66, s79
    s_nop 0
    buffer_load_dwordx4 v4, s[12:15], s26 offen lds
    v_mfma_f32_32x32x16_bf16 v[48:63], v[16:19], v[132:135], v[48:63]
    ds_read_b64_tr_b16 v[28:29], v11 offset:8192
    ds_read_b64_tr_b16 v[30:31], v11 offset:8704
    buffer_load_dwordx4 v5, s[12:15], s26 offen offset:1024 lds
    v_mfma_f32_32x32x16_bf16 v[64:79], v[20:23], v[128:131], v[64:79]
    s_xor_b32 s25, s27, 84992
    buffer_load_dwordx4 v[112:115], v1, s[8:11], s25 offen sc1
    v_mfma_f32_32x32x16_bf16 v[80:95], v[20:23], v[132:135], v[80:95]
    s_xor_b32 s25, s25, 131072
    buffer_load_dwordx4 v[116:119], v1, s[8:11], s25 offen sc1
    s_waitcnt vmcnt(14)
    s_waitcnt lgkmcnt(0)
    s_cmp_eq_u32 s32, 25
    s_cbranch_scc1 K_jit19
K_jitr19:
    v_mfma_f32_32x32x16_bf16 v[32:47], v[24:27], v[136:139], v[32:47]
    ds_read_b64_tr_b16 v[16:17], v10 offset:0
    ds_read_b64_tr_b16 v[18:19], v10 offset:512
    s_add_u32 m0, s24, 8192
    s_add_u32 s26, s67, s76
    s_nop 0
    buffer_load_dwordx4 v4, s[12:15], s26 offen lds
    v_mfma_f32_32x32x16_bf16 v[48:63], v[24:27], v[140:143], v[48:63]
    ds_read_b64_tr_b16 v[20:21], v11 offset:0
    ds_read_b64_tr_b16 v[22:23], v11 offset:512
    buffer_load_dwordx4 v5, s[12:15], s26 offen offset:1024 lds
    v_mfma_f32_32x32x16_bf16 v[64:79], v[28:31], v[136:139], v[64:79]
    s_xor_b32 s25, s27, 98304
    buffer_load_dwordx4 v[120:123], v1, s[8:11], s25 offen sc1
    v_mfma_f32_32x32x16_bf16 v[80:95], v[28:31], v[140:143], v[80:95]
    s_xor_b32 s25, s25, 131072
    buffer_load_dwordx4 v[124:127], v1, s[8:11], s25 offen sc1
    s_waitcnt vmcnt(14)
    s_waitcnt lgkmcnt(0)
    s_cmp_eq_u32 s32, 26
    s_cbranch_scc1 K_jit20
K_jitr20:
    v_mfma_f32_32x32x16_bf16 v[32:47], v[16:19], v[144:147], v[32:47]
    ds_read_b64_tr_b16 v[24:25], v10 offset:2048
    ds_read_b64_tr_b16 v[26:27], v10 offset:2560
    s_add_u32 m0, s24, 0
    s_add_u32 s26, s67, s77
    buffer_load_dwordx4 v4, s[12:15], s26 offen lds
    v_mfma_f32_32x32x16_bf16 v[48:63], v[16:19], v[148:151], v[48:63]
    ds_read_b64_tr_b16 v[28:29], v11 offset:2048
    ds_read_b64_tr_b16 v[30:31], v11 offset:2560
    buffer_load_dwordx4 v5, s[12:15], s26 offen offset:1024 lds
    v_mfma_f32_32x32x16_bf16 v[64:79], v[20:23], v[144:147], v[64:79]
    s_xor_b32 s25, s27, 99328
    buffer_load_dwordx4 v[128:131], v1, s[8:11], s25 offen sc1
    v_mfma_f32_32x32x16_bf16 v[80:95], v[20:23], v[148:151], v[80:95]
    s_xor_b32 s25, s25, 131072
    buffer_load_dwordx4 v[132:135], v1, s[8:11], s25 offen sc1
    s_waitcnt vmcnt(14)
    s_waitcnt lgkmcnt(0)
    s_cmp_eq_u32 s32, 27
    s_cbranch_scc1 K_jit21
K_jitr21:
    v_mfma_f32_32x32x16_bf16 v[32:47], v[24:27], v[96:99], v[32:47]
    ds_read_b64_tr_b16 v[16:17], v10 offset:4096
    ds_read_b64_tr_b16 v[18:19], v10 offset:4608
    s_add_u32 m0, s24, 2048
    s_add_u32 s26, s67, s78
    s_nop 0
    buffer_load_dwordx4 v4, s[12:15], s26 offen lds
    v_mfma_f32_32x32x16_bf16 v[48:63], v[24:27], v[100:103], v[48:63]
    ds_read_b64_tr_b16 v[20:21], v11 offset:4096
    ds_read_b64_tr_b16 v[22:23], v11 offset:4608
    buffer_load_dwordx4 v5, s[12:15], s26 offen offset:1024 lds
    v_mfma_f32_32x32x16_bf16 v[64:79], v[28:31], v[96:99], v[64:79]
    s_xor_b32 s25, s27, 100352
    buffer_load_dwordx4 v[136:139], v1, s[8:11], s25 offen sc1
    v_mfma_f32_32x32x16_bf16 v[80:95], v[28:31], v[100:103], v[80:95]
    s_xor_b32 s25, s25, 131072
    buffer_load_dwordx4 v[140:143], v1, s[8:11], s25 offen sc1
    s_waitcnt vmcnt(14)
    s_waitcnt lgkmcnt(0)
    v_mfma_f32_32x32x16_bf16 v[32:47], v[16:19], v[104:107], v[32:47]
    ds_read_b64_tr_b16 v[24:25], v10 offset:6144
    ds_read_b64_tr_b16 v[26:27], v10 offset:6656
    s_add_u32 m0, s24, 4096
    s_add_u32 s26, s67, s79
    s_nop 0
    buffer_load_dwordx4 v4, s[12:15], s26 offen lds
    v_mfma_f32_32x32x16_bf16 v[48:63], v[16:19], v[108:111], v[48:63]
    ds_read_b64_tr_b16 v[28:29], v11 offset:6144
    ds_read_b64_tr_b16 v[30:31], v11 offset:6656
    buffer_load_dwordx4 v5, s[12:15], s26 offen offset:1024 lds
    v_mfma_f32_32x32x16_bf16 v[64:79], v[20:23], v[104:107], v[64:79]
    s_xor_b32 s25, s27, 101376
    buffer_load_dwordx4 v[144:147], v1, s[8:11], s25 offen sc1
    v_mfma_f32_32x32x16_bf16 v[80:95], v[20:23], v[108:111], v[80:95]
    s_xor_b32 s25, s25, 131072
    buffer_load_dwordx4 v[148:151], v1, s[8:11], s25 offen sc1
    s_waitcnt vmcnt(14)
    s_waitcnt lgkmcnt(0)
    v_mfma_f32_32x32x16_bf16 v[32:47], v[24:27], v[112:115], v[32:47]
    ds_read_b64_tr_b16 v[16:17], v10 offset:8192
    ds_read_b64_tr_b16 v[18:19], v10 offset:8704
    s_add_u32 m0, s24, 6144
    s_add_u32 s26, s68, s76
    s_nop 0
    buffer_load_dwordx4 v4, s[12:15], s26 offen lds
    v_mfma_f32_32x32x16_bf16 v[48:63], v[24:27], v[116:119], v[48:63]
    ds_read_b64_tr_b16 v[20:21], v11 offset:8192
    ds_read_b64_tr_b16 v[22:23], v11 offset:8704
    buffer_load_dwordx4 v5, s[12:15], s26 offen offset:1024 lds
    v_mfma_f32_32x32x16_bf16 v[64:79], v[28:31], v[112:115], v[64:79]
    s_xor_b32 s25, s27, 114688
    buffer_load_dwordx4 v[96:99], v1, s[8:11], s25 offen sc1
    v_mfma_f32_32x32x16_bf16 v[80:95], v[28:31], v[116:119], v[80:95]
    s_xor_b32 s25, s25, 131072
    buffer_load_dwordx4 v[100:103], v1, s[8:11], s25 offen sc1
    s_waitcnt vmcnt(14)
    s_waitcnt lgkmcnt(0)
    s_setprio 3
    v_mfma_f32_32x32x16_bf16 v[32:47], v[16:19], v[120:123], v[32:47]
    s_setprio 0
    ds_read_b64_tr_b16 v[24:25], v10 offset:0
    ds_read_b64_tr_b16 v[26:27], v10 offset:512
    s_add_u32 m0, s24, 8192
    s_add_u32 s26, s68, s77
    buffer_load_dwordx4 v4, s[12:15], s26 offen lds
    s_setprio 3
    v_mfma_f32_32x32x16_bf16 v[48:63], v[16:19], v[124:127], v[48:63]
    s_setprio 0
    s_nop 0
    ds_read_b64_tr_b16 v[28:29], v11 offset:0
    ds_read_b64_tr_b16 v[30:31], v11 offset:512
    buffer_load_dwordx4 v5, s[12:15], s26 offen offset:1024 lds
    v_mfma_f32_32x32x16_bf16 v[64:79], v[20:23], v[120:123], v[64:79]
    s_xor_b32 s25, s27, 115712
    buffer_load_dwordx4 v[104:107], v1, s[8:11], s25 offen sc1
    v_mfma_f32_32x32x16_bf16 v[80:95], v[20:23], v[124:127], v[80:95]
    s_xor_b32 s25, s25, 131072
    buffer_load_dwordx4 v[108:111], v1, s[8:11], s25 offen sc1
    s_waitcnt vmcnt(14)
    s_waitcnt lgkmcnt(0)
    s_setprio 3
    v_mfma_f32_32x32x16_bf16 v[32:47], v[24:27], v[128:131], v[32:47]
    s_setprio 0
    ds_read_b64_tr_b16 v[16:17], v10 offset:2048
    ds_read_b64_tr_b16 v[18:19], v10 offset:2560
    s_add_u32 m0, s24, 0
    s_add_u32 s26, s68, s78
    buffer_load_dwordx4 v4, s[12:15], s26 offen lds
    s_setprio 3
    v_mfma_f32_32x32x16_bf16 v[48:63], v[24:27], v[132:135], v[48:63]
    s_setprio 0
    ds_read_b64_tr_b16 v[20:21], v11 offset:2048
    ds_read_b64_tr_b16 v[22:23], v11 offset:2560
    buffer_load_dwordx4 v5, s[12:15], s26 offen offset:1024 lds
    v_mfma_f32_32x32x16_bf16 v[64:79], v[28:31], v[128:131], v[64:79]
    s_xor_b32 s25, s27, 116736
    buffer_load_dwordx4 v[112:115], v1, s[8:11], s25 offen sc1
    v_mfma_f32_32x32x16_bf16 v[80:95], v[28:31], v[132:135], v[80:95]
    s_xor_b32 s25, s25, 131072
    buffer_load_dwordx4 v[116:119], v1, s[8:11], s25 offen sc1
    s_waitcnt vmcnt(14)
    s_waitcnt lgkmcnt(0)
    s_setprio 3
    v_mfma_f32_32x32x16_bf16 v[32:47], v[16:19], v[136:139], v[32:47]
    s_setprio 0
    ds_read_b64_tr_b16 v[24:25], v10 offset:4096
    ds_read_b64_tr_b16 v[26:27], v10 offset:4608
    s_add_u32 m0, s24, 2048
    s_add_u32 s26, s68, s79
    buffer_load_dwordx4 v4, s[12:15], s26 offen lds
    s_setprio 3
    v_mfma_f32_32x32x16_bf16 v[48:63], v[16:19], v[140:143], v[48:63]
    s_setprio 0
    s_nop 0
    ds_read_b64_tr_b16 v[28:29], v11 offset:4096
    ds_read_b64_tr_b16 v[30:31], v11 offset:4608
    buffer_load_dwordx4 v5, s[12:15], s26 offen offset:1024 lds
    v_mfma_f32_32x32x16_bf16 v[64:79], v[20:23], v[136:139], v[64:79]
    s_xor_b32 s25, s27, 117760
    buffer_load_dwordx4 v[120:123], v1, s[8:11], s25 offen sc1
    v_mfma_f32_32x32x16_bf16 v[80:95], v[20:23], v[140:143], v[80:95]
    s_xor_b32 s25, s25, 131072
    buffer_load_dwordx4 v[124:127], v1, s[8:11], s25 offen sc1
    s_waitcnt vmcnt(14)
    s_waitcnt lgkmcnt(0)
    s_setprio 3
    s_lshl_b32 s33, s20, 2
    v_add_u32 v155, s33, v2
K_mspin:
    ds_read_b32 v153, v155 offset:48
    s_waitcnt lgkmcnt(0)
    v_readfirstlane_b32 s33, v153
    s_cmp_ge_u32 s33, 3
    s_cbranch_scc1 K_mspin_ok
    s_sleep 1
    s_branch K_mspin
K_mspin_ok:
    v_and_b32 v155, 31, v0
    v_lshlrev_b32 v155, 2, v155
    s_setprio 0
    s_lshl_b32 s33, s56, 8
    s_lshl_b32 s34, s59, 7
    s_add_u32 s33, s33, s34
    s_add_u32 s33, s33, 8650752
    s_xor_b32 s34, s33, 128
    buffer_load_dword v152, v155, s[8:11], s33 offen sc1
    buffer_load_dword v154, v155, s[8:11], s34 offen sc1
    s_setprio 3
    v_mfma_f32_32x32x16_bf16 v[32:47], v[24:27], v[144:147], v[32:47]
    s_setprio 0
    ds_read_b64_tr_b16 v[16:17], v10 offset:6144
    ds_read_b64_tr_b16 v[18:19], v10 offset:6656
    s_add_u32 m0, s24, 4096
    s_add_u32 s26, s69, 0
    buffer_load_dwordx4 v6, s[40:43], s26 offen lds
    s_setprio 3
    v_mfma_f32_32x32x16_bf16 v[48:63], v[24:27], v[148:151], v[48:63]
    s_setprio 0
    ds_read_b64_tr_b16 v[20:21], v11 offset:6144
    ds_read_b64_tr_b16 v[22:23], v11 offset:6656
    buffer_load_dwordx4 v7, s[40:43], s26 offen offset:1024 lds
    v_mfma_f32_32x32x16_bf16 v[64:79], v[28:31], v[144:147], v[64:79]
    v_mfma_f32_32x32x16_bf16 v[80:95], v[28:31], v[148:151], v[80:95]
    s_waitcnt vmcnt(14)
    s_waitcnt lgkmcnt(0)
    s_setprio 3
    v_mfma_f32_32x32x16_bf16 v[32:47], v[16:19], v[96:99], v[32:47]
    s_setprio 0
    ds_read_b64_tr_b16 v[24:25], v10 offset:8192
    ds_read_b64_tr_b16 v[26:27], v10 offset:8704
    s_add_u32 m0, s24, 6144
    s_add_u32 s26, s69, 65536
    buffer_load_dwordx4 v6, s[40:43], s26 offen lds
    s_setprio 3
    v_mfma_f32_32x32x16_bf16 v[48:63], v[16:19], v[100:103], v[48:63]
    s_setprio 0
    ds_read_b64_tr_b16 v[28:29], v11 offset:8192
    ds_read_b64_tr_b16 v[30:31], v11 offset:8704
    buffer_load_dwordx4 v7, s[40:43], s26 offen offset:1024 lds
    v_mfma_f32_32x32x16_bf16 v[64:79], v[20:23], v[96:99], v[64:79]
    v_mfma_f32_32x32x16_bf16 v[80:95], v[20:23], v[100:103], v[80:95]
    s_waitcnt vmcnt(12)
    s_waitcnt lgkmcnt(0)
    s_setprio 3
    v_mfma_f32_32x32x16_bf16 v[32:47], v[24:27], v[104:107], v[32:47]
    s_setprio 0
    ds_read_b64_tr_b16 v[16:17], v10 offset:0
    ds_read_b64_tr_b16 v[18:19], v10 offset:512
    s_add_u32 m0, s24, 8192
    s_add_u32 s26, s69, 131072
    buffer_load_dwordx4 v6, s[40:43], s26 offen lds
    s_setprio 3
    v_mfma_f32_32x32x16_bf16 v[48:63], v[24:27], v[108:111], v[48:63]
    s_setprio 0
    ds_read_b64_tr_b16 v[20:21], v11 offset:0
    ds_read_b64_tr_b16 v[22:23], v11 offset:512
    buffer_load_dwordx4 v7, s[40:43], s26 offen offset:1024 lds
    v_mfma_f32_32x32x16_bf16 v[64:79], v[28:31], v[104:107], v[64:79]
    v_mfma_f32_32x32x16_bf16 v[80:95], v[28:31], v[108:111], v[80:95]
    s_waitcnt vmcnt(10)
    s_waitcnt lgkmcnt(0)
    s_setprio 3
    v_mfma_f32_32x32x16_bf16 v[32:47], v[16:19], v[112:115], v[32:47]
    s_setprio 0
    ds_read_b64_tr_b16 v[24:25], v10 offset:2048
    ds_read_b64_tr_b16 v[26:27], v10 offset:2560
    s_add_u32 m0, s24, 0
    s_add_u32 s26, s69, 196608
    buffer_load_dwordx4 v6, s[40:43], s26 offen lds
    s_setprio 3
    v_mfma_f32_32x32x16_bf16 v[48:63], v[16:19], v[116:119], v[48:63]
    s_setprio 0
    ds_read_b64_tr_b16 v[28:29], v11 offset:2048
    ds_read_b64_tr_b16 v[30:31], v11 offset:2560
    buffer_load_dwordx4 v7, s[40:43], s26 offen offset:1024 lds
    v_mfma_f32_32x32x16_bf16 v[64:79], v[20:23], v[112:115], v[64:79]
    v_mfma_f32_32x32x16_bf16 v[80:95], v[20:23], v[116:119], v[80:95]
    s_waitcnt vmcnt(10)
    s_waitcnt lgkmcnt(0)
    s_setprio 3
    v_mfma_f32_32x32x16_bf16 v[48:63], v[24:27], v[124:127], v[48:63]
    s_setprio 0
    s_add_u32 m0, s24, 2048
    s_add_u32 s26, s69, 262144
    buffer_load_dwordx4 v6, s[40:43], s26 offen lds
    s_setprio 3
    v_mfma_f32_32x32x16_bf16 v[64:79], v[28:31], v[120:123], v[64:79]
    s_setprio 0
    buffer_load_dwordx4 v7, s[40:43], s26 offen offset:1024 lds
    v_mfma_f32_32x32x16_bf16 v[80:95], v[28:31], v[124:127], v[80:95]
    v_mfma_f32_32x32x16_bf16 v[32:47], v[24:27], v[120:123], v[32:47]
    s_setprio 3
    s_nop 3
    s_nop 0
    ds_write_b128 v157, v[48:51] offset:10240
    ds_write_b128 v157, v[52:55] offset:11264
    ds_write_b128 v157, v[56:59] offset:12288
    ds_write_b128 v157, v[60:63] offset:13312
    ds_write_b128 v157, v[64:67] offset:14336
    ds_write_b128 v157, v[68:71] offset:15360
    ds_write_b128 v157, v[72:75] offset:16384
    ds_write_b128 v157, v[76:79] offset:17408
    ds_write_b128 v157, v[80:83] offset:18432
    ds_write_b128 v157, v[84:87] offset:19456
    ds_write_b128 v157, v[88:91] offset:20480
    ds_write_b128 v157, v[92:95] offset:21504
    s_waitcnt lgkmcnt(0)
    s_mov_b64 exec, 1
    ds_add_u32 v2, v3
    s_mov_b64 exec, -1
K_gspin:
    ds_read_b32 v153, v2 offset:0
    s_waitcnt lgkmcnt(0)
    v_readfirstlane_b32 s33, v153
    s_cmp_ge_u32 s33, 4
    s_cbranch_scc1 K_gspin_ok
    s_sleep 1
    s_branch K_gspin
K_gspin_ok:
    s_nop 0
    ds_read_b128 v[48:51], v160 offset:10240
    ds_read_b128 v[52:55], v160 offset:11264
    ds_read_b128 v[56:59], v160 offset:12288
    ds_read_b128 v[60:63], v160 offset:13312
    ds_read_b128 v[64:67], v161 offset:14336
    ds_read_b128 v[68:71], v161 offset:15360
    ds_read_b128 v[72:75], v161 offset:16384
    ds_read_b128 v[76:79], v161 offset:17408
    ds_read_b128 v[80:83], v162 offset:18432
    ds_read_b128 v[84:87], v162 offset:19456
    ds_read_b128 v[88:91], v162 offset:20480
    ds_read_b128 v[92:95], v162 offset:21504
    s_waitcnt lgkmcnt(8)
    s_nop 0
    v_pk_add_f32 v[32:33], v[32:33], v[48:49]
    v_pk_add_f32 v[34:35], v[34:35], v[50:51]
    v_pk_add_f32 v[36:37], v[36:37], v[52:53]
    v_pk_add_f32 v[38:39], v[38:39], v[54:55]
    v_pk_add_f32 v[40:41], v[40:41], v[56:57]
    v_pk_add_f32 v[42:43], v[42:43], v[58:59]
    v_pk_add_f32 v[44:45], v[44:45], v[60:61]
    v_pk_add_f32 v[46:47], v[46:47], v[62:63]
    s_waitcnt lgkmcnt(4)
    s_nop 0
    v_pk_add_f32 v[32:33], v[32:33], v[64:65]
    v_pk_add_f32 v[34:35], v[34:35], v[66:67]
    v_pk_add_f32 v[36:37], v[36:37], v[68:69]
    v_pk_add_f32 v[38:39], v[38:39], v[70:71]
    v_pk_add_f32 v[40:41], v[40:41], v[72:73]
    v_pk_add_f32 v[42:43], v[42:43], v[74:75]
    v_pk_add_f32 v[44:45], v[44:45], v[76:77]
    v_pk_add_f32 v[46:47], v[46:47], v[78:79]
    s_waitcnt lgkmcnt(0)
    s_nop 0
    v_pk_add_f32 v[32:33], v[32:33], v[80:81]
    v_pk_add_f32 v[34:35], v[34:35], v[82:83]
    v_pk_add_f32 v[36:37], v[36:37], v[84:85]
    v_pk_add_f32 v[38:39], v[38:39], v[86:87]
    v_pk_add_f32 v[40:41], v[40:41], v[88:89]
    v_pk_add_f32 v[42:43], v[42:43], v[90:91]
    v_pk_add_f32 v[44:45], v[44:45], v[92:93]
    v_pk_add_f32 v[46:47], v[46:47], v[94:95]
    s_mov_b64 exec, 1
    ds_add_u32 v2, v3 offset:4
    s_mov_b64 exec, -1
    v_pk_mul_f32 v[96:97], v[32:33], v[32:33]
    v_pk_mul_f32 v[98:99], v[34:35], v[34:35]
    v_pk_mul_f32 v[100:101], v[36:37], v[36:37]
    v_pk_mul_f32 v[102:103], v[38:39], v[38:39]
    v_pk_mul_f32 v[104:105], v[40:41], v[40:41]
    v_pk_mul_f32 v[106:107], v[42:43], v[42:43]
    v_pk_mul_f32 v[108:109], v[44:45], v[44:45]
    v_pk_mul_f32 v[110:111], v[46:47], v[46:47]
    v_pk_fma_f32 v[96:97], v[96:97], s[74:75], v[158:159] op_sel_hi:[1,1,0]
    v_pk_fma_f32 v[98:99], v[98:99], s[74:75], v[158:159] op_sel_hi:[1,1,0]
    v_pk_fma_f32 v[100:101], v[100:101], s[74:75], v[158:159] op_sel_hi:[1,1,0]
    v_pk_fma_f32 v[102:103], v[102:103], s[74:75], v[158:159] op_sel_hi:[1,1,0]
    v_pk_fma_f32 v[104:105], v[104:105], s[74:75], v[158:159] op_sel_hi:[1,1,0]
    v_pk_fma_f32 v[106:107], v[106:107], s[74:75], v[158:159] op_sel_hi:[1,1,0]
    v_pk_fma_f32 v[108:109], v[108:109], s[74:75], v[158:159] op_sel_hi:[1,1,0]
    v_pk_fma_f32 v[110:111], v[110:111], s[74:75], v[158:159] op_sel_hi:[1,1,0]
    v_pk_mul_f32 v[96:97], v[96:97], v[32:33]
    v_pk_mul_f32 v[98:99], v[98:99], v[34:35]
    v_pk_mul_f32 v[100:101], v[100:101], v[36:37]
    v_pk_mul_f32 v[102:103], v[102:103], v[38:39]
    v_pk_mul_f32 v[104:105], v[104:105], v[40:41]
    v_pk_mul_f32 v[106:107], v[106:107], v[42:43]
    v_pk_mul_f32 v[108:109], v[108:109], v[44:45]
    v_pk_mul_f32 v[110:111], v[110:111], v[46:47]
    v_exp_f32 v96, v96
    v_exp_f32 v97, v97
    v_exp_f32 v98, v98
    v_exp_f32 v99, v99
    v_exp_f32 v100, v100
    v_exp_f32 v101, v101
    v_exp_f32 v102, v102
    v_exp_f32 v103, v103
    v_exp_f32 v104, v104
    v_exp_f32 v105, v105
    v_exp_f32 v106, v106
    v_exp_f32 v107, v107
    v_exp_f32 v108, v108
    v_exp_f32 v109, v109
    v_exp_f32 v110, v110
    v_exp_f32 v111, v111
    v_pk_add_f32 v[96:97], v[96:97], 1.0 op_sel_hi:[1,0]
    v_pk_add_f32 v[98:99], v[98:99], 1.0 op_sel_hi:[1,0]
    v_pk_add_f32 v[100:101], v[100:101], 1.0 op_sel_hi:[1,0]
    v_pk_add_f32 v[102:103], v[102:103], 1.0 op_sel_hi:[1,0]
    v_pk_add_f32 v[104:105], v[104:105], 1.0 op_sel_hi:[1,0]
    v_pk_add_f32 v[106:107], v[106:107], 1.0 op_sel_hi:[1,0]
    v_pk_add_f32 v[108:109], v[108:109], 1.0 op_sel_hi:[1,0]
    v_pk_add_f32 v[110:111], v[110:111], 1.0 op_sel_hi:[1,0]
    v_rcp_f32 v96, v96
    v_rcp_f32 v97, v97
    v_rcp_f32 v98, v98
    v_rcp_f32 v99, v99
    v_rcp_f32 v100, v100
    v_rcp_f32 v101, v101
    v_rcp_f32 v102, v102
    v_rcp_f32 v103, v103
    v_rcp_f32 v104, v104
    v_rcp_f32 v105, v105
    v_rcp_f32 v106, v106
    v_rcp_f32 v107, v107
    v_rcp_f32 v108, v108
    v_rcp_f32 v109, v109
    v_rcp_f32 v110, v110
    v_rcp_f32 v111, v111
    v_pk_mul_f32 v[96:97], v[96:97], v[32:33]
    v_pk_mul_f32 v[98:99], v[98:99], v[34:35]
    v_pk_mul_f32 v[100:101], v[100:101], v[36:37]
    v_pk_mul_f32 v[102:103], v[102:103], v[38:39]
    v_pk_mul_f32 v[104:105], v[104:105], v[40:41]
    v_pk_mul_f32 v[106:107], v[106:107], v[42:43]
    v_pk_mul_f32 v[108:109], v[108:109], v[44:45]
    v_pk_mul_f32 v[110:111], v[110:111], v[46:47]
    v_cvt_pk_bf16_f32 v16, v96, v97
    v_cvt_pk_bf16_f32 v17, v98, v99
    v_cvt_pk_bf16_f32 v18, v100, v101
    v_cvt_pk_bf16_f32 v19, v102, v103
    v_min_u32 v16, -2, v16
    buffer_store_dwordx4 v[16:19], v1, s[8:11], s71 offen offset:0 sc1
    v_cvt_pk_bf16_f32 v20, v104, v105
    v_cvt_pk_bf16_f32 v21, v106, v107
    v_cvt_pk_bf16_f32 v22, v108, v109
    v_cvt_pk_bf16_f32 v23, v110, v111
    v_min_u32 v20, -2, v20
    buffer_store_dwordx4 v[20:23], v1, s[8:11], s71 offen offset:1024 sc1
    s_mul_i32 s33, s20, 7
    s_add_u32 s33, s33, 0
    s_cmp_lg_u32 s33, s31
    s_cbranch_scc1 K_nohint
    s_cmp_lt_u32 s30, 4
    s_cbranch_scc1 K_nohint
    s_lshl_b32 s33, s20, 2
    s_add_u32 s33, s33, s30
    s_lshl_b32 s33, s33, 7
    s_add_u32 s33, s33, 10124800
    s_mov_b64 exec, 1
    buffer_store_dword v3, v1, s[8:11], s33 offen sc1
    s_mov_b64 exec, -1
K_nohint:
K_gspin2:
    ds_read_b32 v153, v2 offset:4
    s_waitcnt lgkmcnt(0)
    v_readfirstlane_b32 s33, v153
    s_cmp_ge_u32 s33, 4
    s_cbranch_scc1 K_gspin2_ok
    s_sleep 1
    s_branch K_gspin2
K_gspin2_ok:
    s_setprio 0
    s_branch K_down
K_no_up:
    s_setprio 3
    v_lshrrev_b32 v96, 2, v0
    v_lshlrev_b32 v97, 7, v136
    v_lshl_add_u32 v96, v96, 12, v97
    v_lshlrev_b32 v97, 7, v0
    v_mov_b32 v98, 0
    s_setprio 0
    s_and_b32 s36, s22, 3
    s_mul_i32 s37, s20, 28
    s_add_u32 s37, s37, s36
    s_lshl_b32 s37, s37, 16
    s_lshl_b32 s34, s21, 9
    s_add_u32 s37, s37, s34
    s_lshl_b32 s38, s20, 2
    s_add_u32 s39, s38, s57
    s_lshl_b32 s39, s39, 7
    s_add_u32 s39, s39, 10124800
    s_add_u32 s38, s38, s36
    s_lshl_b32 s38, s38, 15
    s_add_u32 s35, s36, 4
    s_lshr_b32 s33, s35, 2
    s_xor_b32 s33, s33, s21
    s_lshl_b32 s33, s33, 2
    s_add_u32 s33, s33, s20
    s_lshl_b32 s33, s33, 2
    s_and_b32 s34, s35, 3
    s_add_u32 s33, s33, s34
    s_mul_i32 s33, s33, 57344
    s_mul_i32 s34, s21, 7
    s_lshr_b32 s34, s34, 1
    s_lshl_b32 s34, s34, 7
    s_add_u32 s35, s33, s34
    buffer_load_dword v100, v167, s[12:15], s35 offen
    s_waitcnt vmcnt(0)
    s_add_u32 s35, s36, 8
    s_lshr_b32 s33, s35, 2
    s_xor_b32 s33, s33, s21
    s_lshl_b32 s33, s33, 2
    s_add_u32 s33, s33, s20
    s_lshl_b32 s33, s33, 2
    s_and_b32 s34, s35, 3
    s_add_u32 s33, s33, s34
    s_mul_i32 s33, s33, 57344
    s_mul_i32 s34, s21, 7
    s_lshr_b32 s34, s34, 1
    s_lshl_b32 s34, s34, 7
    s_add_u32 s35, s33, s34
    buffer_load_dword v100, v167, s[12:15], s35 offen
    s_waitcnt vmcnt(0)
    s_add_u32 s34, s37, 0
    buffer_load_dword v100, v96, s[40:43], s34 offen
    s_waitcnt vmcnt(0)
    s_add_u32 s34, s37, 262144
    buffer_load_dword v100, v96, s[40:43], s34 offen
    s_waitcnt vmcnt(0)
    s_add_u32 s34, s37, 524288
    buffer_load_dword v100, v96, s[40:43], s34 offen
    s_waitcnt vmcnt(0)
    s_add_u32 s34, s37, 786432
    buffer_load_dword v100, v96, s[40:43], s34 offen
    s_waitcnt vmcnt(0)
    s_setprio 3
    s_lshl_b32 s33, s20, 2
    v_add_u32 v155, s33, v2
K_mspin2:
    ds_read_b32 v153, v155 offset:48
    s_waitcnt lgkmcnt(0)
    v_readfirstlane_b32 s33, v153
    s_cmp_ge_u32 s33, 3
    s_cbranch_scc1 K_mspin2_ok
    s_sleep 1
    s_branch K_mspin2
K_mspin2_ok:
    v_and_b32 v155, 31, v0
    v_lshlrev_b32 v155, 2, v155
    s_setprio 0
    s_lshl_b32 s33, s56, 8
    s_lshl_b32 s34, s59, 7
    s_add_u32 s33, s33, s34
    s_add_u32 s33, s33, 8650752
    s_xor_b32 s34, s33, 128
    buffer_load_dword v152, v155, s[8:11], s33 offen sc1
    buffer_load_dword v154, v155, s[8:11], s34 offen sc1
    s_add_u32 m0, s24, 4096
    s_add_u32 s26, s69, 0
    s_nop 0
    buffer_load_dwordx4 v6, s[40:43], s26 offen lds
    buffer_load_dwordx4 v7, s[40:43], s26 offen offset:1024 lds
    s_add_u32 m0, s24, 6144
    s_add_u32 s26, s69, 65536
    buffer_load_dwordx4 v6, s[40:43], s26 offen lds
    buffer_load_dwordx4 v7, s[40:43], s26 offen offset:1024 lds
    s_add_u32 m0, s24, 8192
    s_add_u32 s26, s69, 131072
    buffer_load_dwordx4 v6, s[40:43], s26 offen lds
    buffer_load_dwordx4 v7, s[40:43], s26 offen offset:1024 lds
    s_add_u32 m0, s24, 0
    s_nop 0
    s_add_u32 s26, s69, 196608
    buffer_load_dwordx4 v6, s[40:43], s26 offen lds
    buffer_load_dwordx4 v7, s[40:43], s26 offen offset:1024 lds
    s_add_u32 m0, s24, 2048
    s_add_u32 s26, s69, 262144
    buffer_load_dwordx4 v6, s[40:43], s26 offen lds
    buffer_load_dwordx4 v7, s[40:43], s26 offen offset:1024 lds
    s_add_u32 m0, s24, 10240
    s_add_u32 s26, s69, 327680
    buffer_load_dwordx4 v6, s[40:43], s26 offen lds
    buffer_load_dwordx4 v7, s[40:43], s26 offen offset:1024 lds
    s_add_u32 m0, s24, 12288
    s_add_u32 s26, s69, 393216
    buffer_load_dwordx4 v6, s[40:43], s26 offen lds
    buffer_load_dwordx4 v7, s[40:43], s26 offen offset:1024 lds
    s_add_u32 m0, s24, 14336
    s_add_u32 s26, s69, 458752
    buffer_load_dwordx4 v6, s[40:43], s26 offen lds
    buffer_load_dwordx4 v7, s[40:43], s26 offen offset:1024 lds
    s_add_u32 m0, s24, 16384
    s_add_u32 s26, s69, 524288
    buffer_load_dwordx4 v6, s[40:43], s26 offen lds
    buffer_load_dwordx4 v7, s[40:43], s26 offen offset:1024 lds
    s_add_u32 m0, s24, 18432
    s_add_u32 s26, s69, 589824
    buffer_load_dwordx4 v6, s[40:43], s26 offen lds
    buffer_load_dwordx4 v7, s[40:43], s26 offen offset:1024 lds
    s_add_u32 m0, s24, 20480
    s_add_u32 s26, s69, 655360
    buffer_load_dwordx4 v6, s[40:43], s26 offen lds
    buffer_load_dwordx4 v7, s[40:43], s26 offen offset:1024 lds
    s_add_u32 s34, s37, 1048576
    buffer_load_dword v100, v96, s[40:43], s34 offen
    buffer_load_dword v99, v98, s[8:11], s39 offen sc1
    s_waitcnt vmcnt(0)
    s_setprio 3
    v_cmp_eq_u32 vcc, 0, v99
    s_setprio 0
    s_cbranch_vccz K_hint_ok
    s_add_u32 s34, s37, 1310720
    buffer_load_dword v100, v96, s[40:43], s34 offen
    buffer_load_dword v99, v98, s[8:11], s39 offen sc1
    s_waitcnt vmcnt(0)
    s_setprio 3
    v_cmp_eq_u32 vcc, 0, v99
    s_setprio 0
    s_cbranch_vccz K_hint_ok
    s_add_u32 s34, s37, 1572864
    buffer_load_dword v100, v96, s[40:43], s34 offen
    buffer_load_dword v99, v98, s[8:11], s39 offen sc1
    s_waitcnt vmcnt(0)
    s_setprio 3
    v_cmp_eq_u32 vcc, 0, v99
    s_setprio 0
    s_cbranch_vccz K_hint_ok
    s_add_u32 s34, s38, 0
    buffer_load_dword v100, v97, s[44:47], s34 offen
    buffer_load_dword v99, v98, s[8:11], s39 offen sc1
    s_waitcnt vmcnt(0)
    s_setprio 3
    v_cmp_eq_u32 vcc, 0, v99
    s_setprio 0
    s_cbranch_vccz K_hint_ok
    s_add_u32 s34, s38, 8192
    buffer_load_dword v100, v97, s[44:47], s34 offen
    buffer_load_dword v99, v98, s[8:11], s39 offen sc1
    s_waitcnt vmcnt(0)
    s_setprio 3
    v_cmp_eq_u32 vcc, 0, v99
    s_setprio 0
    s_cbranch_vccz K_hint_ok
    s_add_u32 s34, s38, 16384
    buffer_load_dword v100, v97, s[44:47], s34 offen
    buffer_load_dword v99, v98, s[8:11], s39 offen sc1
    s_waitcnt vmcnt(0)
    s_setprio 3
    v_cmp_eq_u32 vcc, 0, v99
    s_setprio 0
    s_cbranch_vccz K_hint_ok
    s_add_u32 s34, s38, 24576
    buffer_load_dword v100, v97, s[44:47], s34 offen
    buffer_load_dword v99, v98, s[8:11], s39 offen sc1
    s_waitcnt vmcnt(0)
    s_setprio 3
    v_cmp_eq_u32 vcc, 0, v99
    s_setprio 0
    s_cbranch_vccz K_hint_ok
    s_setprio 3
K_hint:
    buffer_load_dword v99, v98, s[8:11], s39 offen sc1
K_hint_t:
    s_waitcnt vmcnt(0)
    v_cmp_eq_u32 vcc, 0, v99
    s_cbranch_vccz K_hint_ok
    s_cmp_eq_u32 s60, 0
    s_cbranch_scc1 K_hint_ok
    s_sub_u32 s60, s60, 1
    s_mov_b64 exec, vcc
    s_sleep 8
    s_branch K_hint
K_hint_ok:
    s_mov_b64 exec, -1
    s_setprio 0
    s_branch K_down2
K_down:
    s_nop 0
    s_add_u32 m0, s24, 10240
    s_add_u32 s26, s69, 327680
    buffer_load_dwordx4 v6, s[40:43], s26 offen lds
    buffer_load_dwordx4 v7, s[40:43], s26 offen offset:1024 lds
    s_add_u32 m0, s24, 12288
    s_add_u32 s26, s69, 393216
    buffer_load_dwordx4 v6, s[40:43], s26 offen lds
    buffer_load_dwordx4 v7, s[40:43], s26 offen offset:1024 lds
    s_add_u32 m0, s24, 14336
    s_add_u32 s26, s69, 458752
    buffer_load_dwordx4 v6, s[40:43], s26 offen lds
    buffer_load_dwordx4 v7, s[40:43], s26 offen offset:1024 lds
    s_add_u32 m0, s24, 16384
    s_add_u32 s26, s69, 524288
    buffer_load_dwordx4 v6, s[40:43], s26 offen lds
    buffer_load_dwordx4 v7, s[40:43], s26 offen offset:1024 lds
    s_add_u32 m0, s24, 18432
    s_add_u32 s26, s69, 589824
    buffer_load_dwordx4 v6, s[40:43], s26 offen lds
    buffer_load_dwordx4 v7, s[40:43], s26 offen offset:1024 lds
    s_add_u32 m0, s24, 20480
    s_add_u32 s26, s69, 655360
    buffer_load_dwordx4 v6, s[40:43], s26 offen lds
    buffer_load_dwordx4 v7, s[40:43], s26 offen offset:1024 lds
K_down2:
    s_add_u32 s25, s28, 0
    buffer_load_dwordx4 v[128:131], v1, s[8:11], s25 offen sc1
    s_add_u32 s25, s25, s23
    buffer_load_dwordx4 v[132:135], v1, s[8:11], s25 offen sc1
    s_add_u32 s25, s28, 1024
    buffer_load_dwordx4 v[136:139], v1, s[8:11], s25 offen sc1
    s_add_u32 s25, s25, s23
    buffer_load_dwordx4 v[140:143], v1, s[8:11], s25 offen sc1
    s_add_u32 s25, s28, 2048
    buffer_load_dwordx4 v[144:147], v1, s[8:11], s25 offen sc1
    s_add_u32 s25, s25, s23
    buffer_load_dwordx4 v[148:151], v1, s[8:11], s25 offen sc1
    s_add_u32 s25, s28, 3072
    buffer_load_dwordx4 v[96:99], v1, s[8:11], s25 offen sc1
    s_add_u32 s25, s25, s23
    buffer_load_dwordx4 v[100:103], v1, s[8:11], s25 offen sc1
    s_waitcnt vmcnt(28)
    ds_read_b64_tr_b16 v[16:17], v12 offset:4096
    ds_read_b64_tr_b16 v[18:19], v12 offset:5120
    ds_read_b64_tr_b16 v[20:21], v13 offset:4096
    ds_read_b64_tr_b16 v[22:23], v13 offset:5120
    s_waitcnt vmcnt(6)
    s_setprio 3
    v_max_u32 v153, v128, v132
    v_cmp_eq_u32 vcc, -1, v153
    s_setprio 0
    s_cbranch_vccnz K_c32_wait
K_c32_ok:
    s_waitcnt lgkmcnt(0)
    s_setprio 3
    v_mfma_f32_32x32x16_bf16 v[32:47], v[128:131], v[16:19], 0
    s_setprio 0
    ds_read_b64_tr_b16 v[24:25], v12 offset:6144
    ds_read_b64_tr_b16 v[26:27], v12 offset:7168
    s_add_u32 m0, s24, 4096
    s_add_u32 s26, s69, 720896
    buffer_load_dwordx4 v6, s[40:43], s26 offen lds
    buffer_load_dwordx4 v7, s[40:43], s26 offen offset:1024 lds
    s_setprio 3
    v_mfma_f32_32x32x16_bf16 v[48:63], v[128:131], v[20:23], 0
    s_setprio 0
    ds_read_b64_tr_b16 v[28:29], v13 offset:6144
    ds_read_b64_tr_b16 v[30:31], v13 offset:7168
    s_add_u32 s25, s28, 4096
    buffer_load_dwordx4 v[104:107], v1, s[8:11], s25 offen sc1
    s_add_u32 s25, s25, s23
    buffer_load_dwordx4 v[108:111], v1, s[8:11], s25 offen sc1
    v_mfma_f32_32x32x16_bf16 v[64:79], v[132:135], v[16:19], 0
    s_add_u32 s25, s28, 5120
    buffer_load_dwordx4 v[112:115], v1, s[8:11], s25 offen sc1
    s_add_u32 s25, s25, s23
    buffer_load_dwordx4 v[116:119], v1, s[8:11], s25 offen sc1
    s_waitcnt vmcnt(10)
    s_setprio 3
    v_max_u32 v153, v136, v140
    v_cmp_eq_u32 vcc, -1, v153
    s_setprio 0
    s_cbranch_vccnz K_c33_wait
K_c33_ok:
    v_mfma_f32_32x32x16_bf16 v[80:95], v[132:135], v[20:23], 0
    s_waitcnt lgkmcnt(0)
    s_setprio 3
    v_mfma_f32_32x32x16_bf16 v[32:47], v[136:139], v[24:27], v[32:47]
    s_setprio 0
    ds_read_b64_tr_b16 v[16:17], v12 offset:8192
    ds_read_b64_tr_b16 v[18:19], v12 offset:9216
    s_add_u32 m0, s24, 6144
    s_add_u32 s26, s69, 786432
    buffer_load_dwordx4 v6, s[40:43], s26 offen lds
    buffer_load_dwordx4 v7, s[40:43], s26 offen offset:1024 lds
    s_setprio 3
    v_mfma_f32_32x32x16_bf16 v[48:63], v[136:139], v[28:31], v[48:63]
    s_setprio 0
    ds_read_b64_tr_b16 v[20:21], v13 offset:8192
    ds_read_b64_tr_b16 v[22:23], v13 offset:9216
    s_add_u32 s25, s28, 6144
    buffer_load_dwordx4 v[120:123], v1, s[8:11], s25 offen sc1
    v_mfma_f32_32x32x16_bf16 v[64:79], v[140:143], v[24:27], v[64:79]
    s_add_u32 s25, s25, s23
    buffer_load_dwordx4 v[124:127], v1, s[8:11], s25 offen sc1
    s_waitcnt vmcnt(12)
    s_setprio 3
    v_max_u32 v153, v144, v148
    v_cmp_eq_u32 vcc, -1, v153
    s_setprio 0
    s_cbranch_vccnz K_c34_wait
K_c34_ok:
    v_mfma_f32_32x32x16_bf16 v[80:95], v[140:143], v[28:31], v[80:95]
    s_waitcnt lgkmcnt(0)
    s_setprio 3
    v_mfma_f32_32x32x16_bf16 v[32:47], v[144:147], v[16:19], v[32:47]
    s_setprio 0
    ds_read_b64_tr_b16 v[24:25], v12 offset:0
    ds_read_b64_tr_b16 v[26:27], v12 offset:1024
    s_add_u32 m0, s24, 8192
    s_add_u32 s26, s69, 851968
    buffer_load_dwordx4 v6, s[40:43], s26 offen lds
    buffer_load_dwordx4 v7, s[40:43], s26 offen offset:1024 lds
    s_setprio 3
    v_mfma_f32_32x32x16_bf16 v[48:63], v[144:147], v[20:23], v[48:63]
    s_setprio 0
    ds_read_b64_tr_b16 v[28:29], v13 offset:0
    ds_read_b64_tr_b16 v[30:31], v13 offset:1024
    s_add_u32 s25, s28, 7168
    buffer_load_dwordx4 v[128:131], v1, s[8:11], s25 offen sc1
    v_mfma_f32_32x32x16_bf16 v[64:79], v[148:151], v[16:19], v[64:79]
    s_add_u32 s25, s25, s23
    buffer_load_dwordx4 v[132:135], v1, s[8:11], s25 offen sc1
    s_waitcnt vmcnt(14)
    s_setprio 3
    v_max_u32 v153, v96, v100
    v_cmp_eq_u32 vcc, -1, v153
    s_setprio 0
    s_cbranch_vccnz K_c35_wait
K_c35_ok:
    v_mfma_f32_32x32x16_bf16 v[80:95], v[148:151], v[20:23], v[80:95]
    s_waitcnt lgkmcnt(0)
    s_setprio 3
    v_mfma_f32_32x32x16_bf16 v[32:47], v[96:99], v[24:27], v[32:47]
    s_setprio 0
    ds_read_b64_tr_b16 v[16:17], v12 offset:2048
    ds_read_b64_tr_b16 v[18:19], v12 offset:3072
    s_add_u32 m0, s24, 0
    s_add_u32 s26, s69, 917504
    buffer_load_dwordx4 v6, s[40:43], s26 offen lds
    buffer_load_dwordx4 v7, s[40:43], s26 offen offset:1024 lds
    s_setprio 3
    v_mfma_f32_32x32x16_bf16 v[48:63], v[96:99], v[28:31], v[48:63]
    s_setprio 0
    ds_read_b64_tr_b16 v[20:21], v13 offset:2048
    ds_read_b64_tr_b16 v[22:23], v13 offset:3072
    s_add_u32 s25, s28, 8192
    buffer_load_dwordx4 v[136:139], v1, s[8:11], s25 offen sc1
    v_mfma_f32_32x32x16_bf16 v[64:79], v[100:103], v[24:27], v[64:79]
    s_add_u32 s25, s25, s23
    buffer_load_dwordx4 v[140:143], v1, s[8:11], s25 offen sc1
    s_waitcnt vmcnt(14)
    s_setprio 3
    v_max_u32 v153, v104, v108
    v_cmp_eq_u32 vcc, -1, v153
    s_setprio 0
    s_cbranch_vccnz K_c36_wait
K_c36_ok:
    v_mfma_f32_32x32x16_bf16 v[80:95], v[100:103], v[28:31], v[80:95]
    s_waitcnt lgkmcnt(0)
    s_setprio 3
    v_mfma_f32_32x32x16_bf16 v[32:47], v[104:107], v[16:19], v[32:47]
    s_setprio 0
    ds_read_b64_tr_b16 v[24:25], v12 offset:10240
    ds_read_b64_tr_b16 v[26:27], v12 offset:11264
    s_add_u32 m0, s24, 2048
    s_add_u32 s26, s69, 983040
    buffer_load_dwordx4 v6, s[40:43], s26 offen lds
    buffer_load_dwordx4 v7, s[40:43], s26 offen offset:1024 lds
    s_setprio 3
    v_mfma_f32_32x32x16_bf16 v[48:63], v[104:107], v[20:23], v[48:63]
    s_setprio 0
    ds_read_b64_tr_b16 v[28:29], v13 offset:10240
    ds_read_b64_tr_b16 v[30:31], v13 offset:11264
    s_add_u32 s25, s28, 9216
    buffer_load_dwordx4 v[144:147], v1, s[8:11], s25 offen sc1
    v_mfma_f32_32x32x16_bf16 v[64:79], v[108:111], v[16:19], v[64:79]
    s_add_u32 s25, s25, s23
    buffer_load_dwordx4 v[148:151], v1, s[8:11], s25 offen sc1
    s_waitcnt vmcnt(16)
    s_setprio 3
    v_max_u32 v153, v112, v116
    v_cmp_eq_u32 vcc, -1, v153
    s_setprio 0
    s_cbranch_vccnz K_c37_wait
K_c37_ok:
    v_mfma_f32_32x32x16_bf16 v[80:95], v[108:111], v[20:23], v[80:95]
    s_waitcnt lgkmcnt(0)
    s_setprio 3
    v_mfma_f32_32x32x16_bf16 v[32:47], v[112:115], v[24:27], v[32:47]
    s_setprio 0
    ds_read_b64_tr_b16 v[16:17], v12 offset:12288
    ds_read_b64_tr_b16 v[18:19], v12 offset:13312
    s_add_u32 m0, s24, 10240
    s_add_u32 s26, s69, 1048576
    buffer_load_dwordx4 v6, s[40:43], s26 offen lds
    buffer_load_dwordx4 v7, s[40:43], s26 offen offset:1024 lds
    s_setprio 3
    v_mfma_f32_32x32x16_bf16 v[48:63], v[112:115], v[28:31], v[48:63]
    s_setprio 0
    ds_read_b64_tr_b16 v[20:21], v13 offset:12288
    ds_read_b64_tr_b16 v[22:23], v13 offset:13312
    s_add_u32 s25, s28, 10240
    buffer_load_dwordx4 v[96:99], v1, s[8:11], s25 offen sc1
    v_mfma_f32_32x32x16_bf16 v[64:79], v[116:119], v[24:27], v[64:79]
    s_add_u32 s25, s25, s23
    buffer_load_dwordx4 v[100:103], v1, s[8:11], s25 offen sc1
    s_waitcnt vmcnt(16)
    s_setprio 3
    v_max_u32 v153, v120, v124
    v_cmp_eq_u32 vcc, -1, v153
    s_setprio 0
    s_cbranch_vccnz K_c38_wait
K_c38_ok:
    v_mfma_f32_32x32x16_bf16 v[80:95], v[116:119], v[28:31], v[80:95]
    s_waitcnt lgkmcnt(0)
    s_setprio 3
    v_mfma_f32_32x32x16_bf16 v[32:47], v[120:123], v[16:19], v[32:47]
    s_setprio 0
    ds_read_b64_tr_b16 v[24:25], v12 offset:14336
    ds_read_b64_tr_b16 v[26:27], v12 offset:15360
    s_add_u32 m0, s24, 12288
    s_add_u32 s26, s69, 1114112
    buffer_load_dwordx4 v6, s[40:43], s26 offen lds
    buffer_load_dwordx4 v7, s[40:43], s26 offen offset:1024 lds
    s_setprio 3
    v_mfma_f32_32x32x16_bf16 v[48:63], v[120:123], v[20:23], v[48:63]
    s_setprio 0
    ds_read_b64_tr_b16 v[28:29], v13 offset:14336
    ds_read_b64_tr_b16 v[30:31], v13 offset:15360
    s_add_u32 s25, s28, 11264
    buffer_load_dwordx4 v[104:107], v1, s[8:11], s25 offen sc1
    v_mfma_f32_32x32x16_bf16 v[64:79], v[124:127], v[16:19], v[64:79]
    s_add_u32 s25, s25, s23
    buffer_load_dwordx4 v[108:111], v1, s[8:11], s25 offen sc1
    s_waitcnt vmcnt(16)
    s_setprio 3
    v_max_u32 v153, v128, v132
    v_cmp_eq_u32 vcc, -1, v153
    s_setprio 0
    s_cbranch_vccnz K_c39_wait
K_c39_ok:
    v_mfma_f32_32x32x16_bf16 v[80:95], v[124:127], v[20:23], v[80:95]
    s_waitcnt lgkmcnt(0)
    s_setprio 3
    v_mfma_f32_32x32x16_bf16 v[32:47], v[128:131], v[24:27], v[32:47]
    s_setprio 0
    ds_read_b64_tr_b16 v[16:17], v12 offset:16384
    ds_read_b64_tr_b16 v[18:19], v12 offset:17408
    s_add_u32 m0, s24, 14336
    s_add_u32 s26, s69, 1179648
    buffer_load_dwordx4 v6, s[40:43], s26 offen lds
    buffer_load_dwordx4 v7, s[40:43], s26 offen offset:1024 lds
    s_setprio 3
    v_mfma_f32_32x32x16_bf16 v[48:63], v[128:131], v[28:31], v[48:63]
    s_setprio 0
    ds_read_b64_tr_b16 v[20:21], v13 offset:16384
    ds_read_b64_tr_b16 v[22:23], v13 offset:17408
    s_add_u32 s25, s28, 12288
    buffer_load_dwordx4 v[112:115], v1, s[8:11], s25 offen sc1
    v_mfma_f32_32x32x16_bf16 v[64:79], v[132:135], v[24:27], v[64:79]
    s_add_u32 s25, s25, s23
    buffer_load_dwordx4 v[116:119], v1, s[8:11], s25 offen sc1
    s_waitcnt vmcnt(16)
    s_setprio 3
    v_max_u32 v153, v136, v140
    v_cmp_eq_u32 vcc, -1, v153
    s_setprio 0
    s_cbranch_vccnz K_c40_wait
K_c40_ok:
    v_mfma_f32_32x32x16_bf16 v[80:95], v[132:135], v[28:31], v[80:95]
    s_waitcnt lgkmcnt(0)
    s_setprio 3
    v_mfma_f32_32x32x16_bf16 v[32:47], v[136:139], v[16:19], v[32:47]
    s_setprio 0
    ds_read_b64_tr_b16 v[24:25], v12 offset:18432
    ds_read_b64_tr_b16 v[26:27], v12 offset:19456
    s_add_u32 m0, s24, 16384
    s_add_u32 s26, s69, 1245184
    buffer_load_dwordx4 v6, s[40:43], s26 offen lds
    buffer_load_dwordx4 v7, s[40:43], s26 offen offset:1024 lds
    s_setprio 3
    v_mfma_f32_32x32x16_bf16 v[48:63], v[136:139], v[20:23], v[48:63]
    s_setprio 0
    ds_read_b64_tr_b16 v[28:29], v13 offset:18432
    ds_read_b64_tr_b16 v[30:31], v13 offset:19456
    s_add_u32 s25, s28, 13312
    buffer_load_dwordx4 v[120:123], v1, s[8:11], s25 offen sc1
    v_mfma_f32_32x32x16_bf16 v[64:79], v[140:143], v[16:19], v[64:79]
    s_add_u32 s25, s25, s23
    buffer_load_dwordx4 v[124:127], v1, s[8:11], s25 offen sc1
    s_waitcnt vmcnt(16)
    s_setprio 3
    v_max_u32 v153, v144, v148
    v_cmp_eq_u32 vcc, -1, v153
    s_setprio 0
    s_cbranch_vccnz K_c41_wait
K_c41_ok:
    v_mfma_f32_32x32x16_bf16 v[80:95], v[140:143], v[20:23], v[80:95]
    s_waitcnt lgkmcnt(0)
    s_setprio 3
    v_mfma_f32_32x32x16_bf16 v[32:47], v[144:147], v[24:27], v[32:47]
    s_setprio 0
    ds_read_b64_tr_b16 v[16:17], v12 offset:20480
    ds_read_b64_tr_b16 v[18:19], v12 offset:21504
    s_add_u32 m0, s24, 18432
    s_add_u32 s26, s69, 1310720
    buffer_load_dwordx4 v6, s[40:43], s26 offen lds
    buffer_load_dwordx4 v7, s[40:43], s26 offen offset:1024 lds
    s_setprio 3
    v_mfma_f32_32x32x16_bf16 v[48:63], v[144:147], v[28:31], v[48:63]
    s_setprio 0
    ds_read_b64_tr_b16 v[20:21], v13 offset:20480
    ds_read_b64_tr_b16 v[22:23], v13 offset:21504
    s_add_u32 s25, s28, 14336
    buffer_load_dwordx4 v[128:131], v1, s[8:11], s25 offen sc1
    v_mfma_f32_32x32x16_bf16 v[64:79], v[148:151], v[24:27], v[64:79]
    s_add_u32 s25, s25, s23
    buffer_load_dwordx4 v[132:135], v1, s[8:11], s25 offen sc1
    s_waitcnt vmcnt(16)
    s_setprio 3
    v_max_u32 v153, v96, v100
    v_cmp_eq_u32 vcc, -1, v153
    s_setprio 0
    s_cbranch_vccnz K_c42_wait
K_c42_ok:
    v_mfma_f32_32x32x16_bf16 v[80:95], v[148:151], v[28:31], v[80:95]
    s_waitcnt lgkmcnt(0)
    s_setprio 3
    v_mfma_f32_32x32x16_bf16 v[32:47], v[96:99], v[16:19], v[32:47]
    s_setprio 0
    ds_read_b64_tr_b16 v[24:25], v12 offset:4096
    ds_read_b64_tr_b16 v[26:27], v12 offset:5120
    s_add_u32 m0, s24, 20480
    s_add_u32 s26, s69, 1376256
    buffer_load_dwordx4 v6, s[40:43], s26 offen lds
    buffer_load_dwordx4 v7, s[40:43], s26 offen offset:1024 lds
    s_setprio 3
    v_mfma_f32_32x32x16_bf16 v[48:63], v[96:99], v[20:23], v[48:63]
    s_setprio 0
    ds_read_b64_tr_b16 v[28:29], v13 offset:4096
    ds_read_b64_tr_b16 v[30:31], v13 offset:5120
    s_add_u32 s25, s28, 15360
    buffer_load_dwordx4 v[136:139], v1, s[8:11], s25 offen sc1
    v_mfma_f32_32x32x16_bf16 v[64:79], v[100:103], v[16:19], v[64:79]
    s_add_u32 s25, s25, s23
    buffer_load_dwordx4 v[140:143], v1, s[8:11], s25 offen sc1
    s_waitcnt vmcnt(16)
    s_setprio 3
    v_max_u32 v153, v104, v108
    v_cmp_eq_u32 vcc, -1, v153
    s_setprio 0
    s_cbranch_vccnz K_c43_wait
K_c43_ok:
    v_mfma_f32_32x32x16_bf16 v[80:95], v[100:103], v[20:23], v[80:95]
    s_waitcnt lgkmcnt(0)
    s_setprio 3
    v_mfma_f32_32x32x16_bf16 v[32:47], v[104:107], v[24:27], v[32:47]
    s_setprio 0
    ds_read_b64_tr_b16 v[16:17], v12 offset:6144
    ds_read_b64_tr_b16 v[18:19], v12 offset:7168
    s_add_u32 m0, s24, 4096
    s_add_u32 s26, s69, 1441792
    buffer_load_dwordx4 v6, s[40:43], s26 offen lds
    buffer_load_dwordx4 v7, s[40:43], s26 offen offset:1024 lds
    s_setprio 3
    v_mfma_f32_32x32x16_bf16 v[48:63], v[104:107], v[28:31], v[48:63]
    s_setprio 0
    ds_read_b64_tr_b16 v[20:21], v13 offset:6144
    ds_read_b64_tr_b16 v[22:23], v13 offset:7168
    s_add_u32 s25, s28, 16384
    buffer_load_dwordx4 v[144:147], v1, s[8:11], s25 offen sc1
    v_mfma_f32_32x32x16_bf16 v[64:79], v[108:111], v[24:27], v[64:79]
    s_add_u32 s25, s25, s23
    buffer_load_dwordx4 v[148:151], v1, s[8:11], s25 offen sc1
    s_waitcnt vmcnt(16)
    s_setprio 3
    v_max_u32 v153, v112, v116
    v_cmp_eq_u32 vcc, -1, v153
    s_setprio 0
    s_cbranch_vccnz K_c44_wait
K_c44_ok:
    v_mfma_f32_32x32x16_bf16 v[80:95], v[108:111], v[28:31], v[80:95]
    s_waitcnt lgkmcnt(0)
    s_setprio 3
    v_mfma_f32_32x32x16_bf16 v[32:47], v[112:115], v[16:19], v[32:47]
    s_setprio 0
    ds_read_b64_tr_b16 v[24:25], v12 offset:8192
    ds_read_b64_tr_b16 v[26:27], v12 offset:9216
    s_add_u32 m0, s24, 6144
    s_add_u32 s26, s69, 1507328
    buffer_load_dwordx4 v6, s[40:43], s26 offen lds
    buffer_load_dwordx4 v7, s[40:43], s26 offen offset:1024 lds
    s_setprio 3
    v_mfma_f32_32x32x16_bf16 v[48:63], v[112:115], v[20:23], v[48:63]
    s_setprio 0
    ds_read_b64_tr_b16 v[28:29], v13 offset:8192
    ds_read_b64_tr_b16 v[30:31], v13 offset:9216
    s_add_u32 s25, s28, 17408
    buffer_load_dwordx4 v[96:99], v1, s[8:11], s25 offen sc1
    v_mfma_f32_32x32x16_bf16 v[64:79], v[116:119], v[16:19], v[64:79]
    s_add_u32 s25, s25, s23
    buffer_load_dwordx4 v[100:103], v1, s[8:11], s25 offen sc1
    s_waitcnt vmcnt(16)
    s_setprio 3
    v_max_u32 v153, v120, v124
    v_cmp_eq_u32 vcc, -1, v153
    s_setprio 0
    s_cbranch_vccnz K_c45_wait
K_c45_ok:
    v_mfma_f32_32x32x16_bf16 v[80:95], v[116:119], v[20:23], v[80:95]
    s_waitcnt lgkmcnt(0)
    s_setprio 3
    v_mfma_f32_32x32x16_bf16 v[32:47], v[120:123], v[24:27], v[32:47]
    s_setprio 0
    ds_read_b64_tr_b16 v[16:17], v12 offset:0
    ds_read_b64_tr_b16 v[18:19], v12 offset:1024
    s_add_u32 m0, s24, 8192
    s_add_u32 s26, s69, 1572864
    buffer_load_dwordx4 v6, s[40:43], s26 offen lds
    buffer_load_dwordx4 v7, s[40:43], s26 offen offset:1024 lds
    s_setprio 3
    v_mfma_f32_32x32x16_bf16 v[48:63], v[120:123], v[28:31], v[48:63]
    s_setprio 0
    ds_read_b64_tr_b16 v[20:21], v13 offset:0
    ds_read_b64_tr_b16 v[22:23], v13 offset:1024
    s_add_u32 s25, s28, 18432
    buffer_load_dwordx4 v[104:107], v1, s[8:11], s25 offen sc1
    v_mfma_f32_32x32x16_bf16 v[64:79], v[124:127], v[24:27], v[64:79]
    s_add_u32 s25, s25, s23
    buffer_load_dwordx4 v[108:111], v1, s[8:11], s25 offen sc1
    s_waitcnt vmcnt(16)
    s_setprio 3
    v_max_u32 v153, v128, v132
    v_cmp_eq_u32 vcc, -1, v153
    s_setprio 0
    s_cbranch_vccnz K_c46_wait
K_c46_ok:
    v_mfma_f32_32x32x16_bf16 v[80:95], v[124:127], v[28:31], v[80:95]
    s_waitcnt lgkmcnt(0)
    s_setprio 3
    v_mfma_f32_32x32x16_bf16 v[32:47], v[128:131], v[16:19], v[32:47]
    s_setprio 0
    ds_read_b64_tr_b16 v[24:25], v12 offset:2048
    ds_read_b64_tr_b16 v[26:27], v12 offset:3072
    s_add_u32 m0, s24, 0
    s_add_u32 s26, s69, 1638400
    buffer_load_dwordx4 v6, s[40:43], s26 offen lds
    buffer_load_dwordx4 v7, s[40:43], s26 offen offset:1024 lds
    s_setprio 3
    v_mfma_f32_32x32x16_bf16 v[48:63], v[128:131], v[20:23], v[48:63]
    s_setprio 0
    ds_read_b64_tr_b16 v[28:29], v13 offset:2048
    ds_read_b64_tr_b16 v[30:31], v13 offset:3072
    s_add_u32 s25, s28, 19456
    buffer_load_dwordx4 v[112:115], v1, s[8:11], s25 offen sc1
    v_mfma_f32_32x32x16_bf16 v[64:79], v[132:135], v[16:19], v[64:79]
    s_add_u32 s25, s25, s23
    buffer_load_dwordx4 v[116:119], v1, s[8:11], s25 offen sc1
    s_waitcnt vmcnt(16)
    s_setprio 3
    v_max_u32 v153, v136, v140
    v_cmp_eq_u32 vcc, -1, v153
    s_setprio 0
    s_cbranch_vccnz K_c47_wait
K_c47_ok:
    v_mfma_f32_32x32x16_bf16 v[80:95], v[132:135], v[20:23], v[80:95]
    s_waitcnt lgkmcnt(0)
    s_setprio 3
    v_mfma_f32_32x32x16_bf16 v[32:47], v[136:139], v[24:27], v[32:47]
    s_setprio 0
    ds_read_b64_tr_b16 v[16:17], v12 offset:10240
    ds_read_b64_tr_b16 v[18:19], v12 offset:11264
    s_add_u32 m0, s24, 2048
    s_add_u32 s26, s69, 1703936
    buffer_load_dwordx4 v6, s[40:43], s26 offen lds
    buffer_load_dwordx4 v7, s[40:43], s26 offen offset:1024 lds
    s_setprio 3
    v_mfma_f32_32x32x16_bf16 v[48:63], v[136:139], v[28:31], v[48:63]
    s_setprio 0
    ds_read_b64_tr_b16 v[20:21], v13 offset:10240
    ds_read_b64_tr_b16 v[22:23], v13 offset:11264
    s_add_u32 s25, s28, 20480
    buffer_load_dwordx4 v[120:123], v1, s[8:11], s25 offen sc1
    v_mfma_f32_32x32x16_bf16 v[64:79], v[140:143], v[24:27], v[64:79]
    s_add_u32 s25, s25, s23
    buffer_load_dwordx4 v[124:127], v1, s[8:11], s25 offen sc1
    s_waitcnt vmcnt(16)
    s_setprio 3
    v_max_u32 v153, v144, v148
    v_cmp_eq_u32 vcc, -1, v153
    s_setprio 0
    s_cbranch_vccnz K_c48_wait
K_c48_ok:
    v_mfma_f32_32x32x16_bf16 v[80:95], v[140:143], v[28:31], v[80:95]
    s_waitcnt lgkmcnt(0)
    s_setprio 3
    v_mfma_f32_32x32x16_bf16 v[32:47], v[144:147], v[16:19], v[32:47]
    s_setprio 0
    ds_read_b64_tr_b16 v[24:25], v12 offset:12288
    ds_read_b64_tr_b16 v[26:27], v12 offset:13312
    s_add_u32 m0, s24, 10240
    s_add_u32 s26, s69, 1769472
    buffer_load_dwordx4 v6, s[40:43], s26 offen lds
    buffer_load_dwordx4 v7, s[40:43], s26 offen offset:1024 lds
    s_setprio 3
    v_mfma_f32_32x32x16_bf16 v[48:63], v[144:147], v[20:23], v[48:63]
    s_setprio 0
    ds_read_b64_tr_b16 v[28:29], v13 offset:12288
    ds_read_b64_tr_b16 v[30:31], v13 offset:13312
    s_add_u32 s25, s28, 21504
    buffer_load_dwordx4 v[128:131], v1, s[8:11], s25 offen sc1
    v_mfma_f32_32x32x16_bf16 v[64:79], v[148:151], v[16:19], v[64:79]
    s_add_u32 s25, s25, s23
    buffer_load_dwordx4 v[132:135], v1, s[8:11], s25 offen sc1
    s_waitcnt vmcnt(16)
    s_setprio 3
    v_max_u32 v153, v96, v100
    v_cmp_eq_u32 vcc, -1, v153
    s_setprio 0
    s_cbranch_vccnz K_c49_wait
K_c49_ok:
    v_mfma_f32_32x32x16_bf16 v[80:95], v[148:151], v[20:23], v[80:95]
    s_waitcnt lgkmcnt(0)
    s_setprio 3
    v_mfma_f32_32x32x16_bf16 v[32:47], v[96:99], v[24:27], v[32:47]
    s_setprio 0
    ds_read_b64_tr_b16 v[16:17], v12 offset:14336
    ds_read_b64_tr_b16 v[18:19], v12 offset:15360
    s_add_u32 m0, s24, 12288
    s_add_u32 s26, s70, 0
    buffer_load_dwordx4 v8, s[44:47], s26 offen lds
    buffer_load_dwordx4 v9, s[44:47], s26 offen offset:1024 lds
    s_setprio 3
    v_mfma_f32_32x32x16_bf16 v[48:63], v[96:99], v[28:31], v[48:63]
    s_setprio 0
    ds_read_b64_tr_b16 v[20:21], v13 offset:14336
    ds_read_b64_tr_b16 v[22:23], v13 offset:15360
    s_add_u32 s25, s28, 22528
    buffer_load_dwordx4 v[136:139], v1, s[8:11], s25 offen sc1
    v_mfma_f32_32x32x16_bf16 v[64:79], v[100:103], v[24:27], v[64:79]
    s_add_u32 s25, s25, s23
    buffer_load_dwordx4 v[140:143], v1, s[8:11], s25 offen sc1
    s_waitcnt vmcnt(16)
    s_setprio 3
    v_max_u32 v153, v104, v108
    v_cmp_eq_u32 vcc, -1, v153
    s_setprio 0
    s_cbranch_vccnz K_c50_wait
K_c50_ok:
    v_mfma_f32_32x32x16_bf16 v[80:95], v[100:103], v[28:31], v[80:95]
    s_waitcnt lgkmcnt(0)
    s_setprio 3
    v_mfma_f32_32x32x16_bf16 v[32:47], v[104:107], v[16:19], v[32:47]
    s_setprio 0
    ds_read_b64_tr_b16 v[24:25], v12 offset:16384
    ds_read_b64_tr_b16 v[26:27], v12 offset:17408
    s_add_u32 m0, s24, 14336
    s_add_u32 s26, s70, 16384
    buffer_load_dwordx4 v8, s[44:47], s26 offen lds
    buffer_load_dwordx4 v9, s[44:47], s26 offen offset:1024 lds
    s_setprio 3
    v_mfma_f32_32x32x16_bf16 v[48:63], v[104:107], v[20:23], v[48:63]
    s_setprio 0
    ds_read_b64_tr_b16 v[28:29], v13 offset:16384
    ds_read_b64_tr_b16 v[30:31], v13 offset:17408
    s_add_u32 s25, s28, 23552
    buffer_load_dwordx4 v[144:147], v1, s[8:11], s25 offen sc1
    v_mfma_f32_32x32x16_bf16 v[64:79], v[108:111], v[16:19], v[64:79]
    s_add_u32 s25, s25, s23
    buffer_load_dwordx4 v[148:151], v1, s[8:11], s25 offen sc1
    s_waitcnt vmcnt(16)
    s_setprio 3
    v_max_u32 v153, v112, v116
    v_cmp_eq_u32 vcc, -1, v153
    s_setprio 0
    s_cbranch_vccnz K_c51_wait
K_c51_ok:
    v_mfma_f32_32x32x16_bf16 v[80:95], v[108:111], v[20:23], v[80:95]
    s_waitcnt lgkmcnt(0)
    s_setprio 3
    v_mfma_f32_32x32x16_bf16 v[32:47], v[112:115], v[24:27], v[32:47]
    s_setprio 0
    ds_read_b64_tr_b16 v[16:17], v12 offset:18432
    ds_read_b64_tr_b16 v[18:19], v12 offset:19456
    s_add_u32 m0, s24, 16384
    s_add_u32 s26, s70, 65536
    buffer_load_dwordx4 v8, s[44:47], s26 offen lds
    buffer_load_dwordx4 v9, s[44:47], s26 offen offset:1024 lds
    s_setprio 3
    v_mfma_f32_32x32x16_bf16 v[48:63], v[112:115], v[28:31], v[48:63]
    s_setprio 0
    ds_read_b64_tr_b16 v[20:21], v13 offset:18432
    ds_read_b64_tr_b16 v[22:23], v13 offset:19456
    s_add_u32 s25, s28, 24576
    buffer_load_dwordx4 v[96:99], v1, s[8:11], s25 offen sc1
    v_mfma_f32_32x32x16_bf16 v[64:79], v[116:119], v[24:27], v[64:79]
    s_add_u32 s25, s25, s23
    buffer_load_dwordx4 v[100:103], v1, s[8:11], s25 offen sc1
    s_waitcnt vmcnt(16)
    s_setprio 3
    v_max_u32 v153, v120, v124
    v_cmp_eq_u32 vcc, -1, v153
    s_setprio 0
    s_cbranch_vccnz K_c52_wait
K_c52_ok:
    v_mfma_f32_32x32x16_bf16 v[80:95], v[116:119], v[28:31], v[80:95]
    s_waitcnt lgkmcnt(0)
    s_setprio 3
    v_mfma_f32_32x32x16_bf16 v[32:47], v[120:123], v[16:19], v[32:47]
    s_setprio 0
    ds_read_b64_tr_b16 v[24:25], v12 offset:20480
    ds_read_b64_tr_b16 v[26:27], v12 offset:21504
    s_add_u32 m0, s24, 18432
    s_add_u32 s26, s70, 81920
    buffer_load_dwordx4 v8, s[44:47], s26 offen lds
    buffer_load_dwordx4 v9, s[44:47], s26 offen offset:1024 lds
    s_setprio 3
    v_mfma_f32_32x32x16_bf16 v[48:63], v[120:123], v[20:23], v[48:63]
    s_setprio 0
    ds_read_b64_tr_b16 v[28:29], v13 offset:20480
    ds_read_b64_tr_b16 v[30:31], v13 offset:21504
    s_add_u32 s25, s28, 25600
    buffer_load_dwordx4 v[104:107], v1, s[8:11], s25 offen sc1
    v_mfma_f32_32x32x16_bf16 v[64:79], v[124:127], v[16:19], v[64:79]
    s_add_u32 s25, s25, s23
    buffer_load_dwordx4 v[108:111], v1, s[8:11], s25 offen sc1
    s_waitcnt vmcnt(16)
    s_setprio 3
    v_max_u32 v153, v128, v132
    v_cmp_eq_u32 vcc, -1, v153
    s_setprio 0
    s_cbranch_vccnz K_c53_wait
K_c53_ok:
    v_mfma_f32_32x32x16_bf16 v[80:95], v[124:127], v[20:23], v[80:95]
    s_waitcnt lgkmcnt(0)
    s_setprio 3
    v_mfma_f32_32x32x16_bf16 v[32:47], v[128:131], v[24:27], v[32:47]
    s_setprio 0
    ds_read_b64_tr_b16 v[16:17], v12 offset:4096
    ds_read_b64_tr_b16 v[18:19], v12 offset:5120
    s_add_u32 m0, s24, 20480
    s_add_u32 s26, s70, 32768
    buffer_load_dwordx4 v8, s[44:47], s26 offen lds
    buffer_load_dwordx4 v9, s[44:47], s26 offen offset:1024 lds
    s_setprio 3
    v_mfma_f32_32x32x16_bf16 v[48:63], v[128:131], v[28:31], v[48:63]
    s_setprio 0
    ds_read_b64_tr_b16 v[20:21], v13 offset:4096
    ds_read_b64_tr_b16 v[22:23], v13 offset:5120
    s_add_u32 s25, s28, 26624
    buffer_load_dwordx4 v[112:115], v1, s[8:11], s25 offen sc1
    v_mfma_f32_32x32x16_bf16 v[64:79], v[132:135], v[24:27], v[64:79]
    s_add_u32 s25, s25, s23
    buffer_load_dwordx4 v[116:119], v1, s[8:11], s25 offen sc1
    s_waitcnt vmcnt(16)
    s_setprio 3
    v_max_u32 v153, v136, v140
    v_cmp_eq_u32 vcc, -1, v153
    s_setprio 0
    s_cbranch_vccnz K_c54_wait
K_c54_ok:
    v_mfma_f32_32x32x16_bf16 v[80:95], v[132:135], v[28:31], v[80:95]
    s_waitcnt lgkmcnt(0)
    s_setprio 3
    v_mfma_f32_32x32x16_bf16 v[32:47], v[136:139], v[16:19], v[32:47]
    s_setprio 0
    ds_read_b64_tr_b16 v[24:25], v12 offset:6144
    ds_read_b64_tr_b16 v[26:27], v12 offset:7168
    s_add_u32 m0, s24, 4096
    s_add_u32 s26, s70, 49152
    buffer_load_dwordx4 v8, s[44:47], s26 offen lds
    buffer_load_dwordx4 v9, s[44:47], s26 offen offset:1024 lds
    s_setprio 3
    v_mfma_f32_32x32x16_bf16 v[48:63], v[136:139], v[20:23], v[48:63]
    s_setprio 0
    ds_read_b64_tr_b16 v[28:29], v13 offset:6144
    ds_read_b64_tr_b16 v[30:31], v13 offset:7168
    s_add_u32 s25, s28, 27648
    buffer_load_dwordx4 v[120:123], v1, s[8:11], s25 offen sc1
    v_mfma_f32_32x32x16_bf16 v[64:79], v[140:143], v[16:19], v[64:79]
    s_add_u32 s25, s25, s23
    buffer_load_dwordx4 v[124:127], v1, s[8:11], s25 offen sc1
    s_waitcnt vmcnt(16)
    s_setprio 3
    v_max_u32 v153, v144, v148
    v_cmp_eq_u32 vcc, -1, v153
    s_setprio 0
    s_cbranch_vccnz K_c55_wait
K_c55_ok:
    v_mfma_f32_32x32x16_bf16 v[80:95], v[140:143], v[20:23], v[80:95]
    s_waitcnt lgkmcnt(0)
    s_setprio 3
K_hold:
    ds_read_b32 v153, v2 offset:20
    s_waitcnt lgkmcnt(0)
    v_readfirstlane_b32 s33, v153
    s_cmp_ge_u32 s33, 4
    s_cbranch_scc1 K_hold_ok
    s_sleep 1
    s_branch K_hold
K_hold_ok:
    s_setprio 0
    s_setprio 3
    v_mfma_f32_32x32x16_bf16 v[32:47], v[144:147], v[24:27], v[32:47]
    s_setprio 0
    ds_read_b64_tr_b16 v[16:17], v12 offset:8192
    ds_read_b64_tr_b16 v[18:19], v12 offset:9216
    s_add_u32 m0, s24, 6144
    s_add_u32 s26, s70, 98304
    buffer_load_dwordx4 v8, s[44:47], s26 offen lds
    buffer_load_dwordx4 v9, s[44:47], s26 offen offset:1024 lds
    s_setprio 3
    v_mfma_f32_32x32x16_bf16 v[48:63], v[144:147], v[28:31], v[48:63]
    s_setprio 0
    ds_read_b64_tr_b16 v[20:21], v13 offset:8192
    ds_read_b64_tr_b16 v[22:23], v13 offset:9216
    s_add_u32 s25, s29, 0
    buffer_load_dwordx4 v[128:131], v1, s[8:11], s25 offen sc1
    v_mfma_f32_32x32x16_bf16 v[64:79], v[148:151], v[24:27], v[64:79]
    s_xor_b32 s25, s25, 32768
    buffer_load_dwordx4 v[132:135], v1, s[8:11], s25 offen sc1
    s_waitcnt vmcnt(16)
    s_setprio 3
    v_max_u32 v153, v96, v100
    v_cmp_eq_u32 vcc, -1, v153
    s_setprio 0
    s_cbranch_vccnz K_c56_wait
K_c56_ok:
    v_mfma_f32_32x32x16_bf16 v[80:95], v[148:151], v[28:31], v[80:95]
    s_waitcnt lgkmcnt(0)
    s_setprio 3
    v_mfma_f32_32x32x16_bf16 v[32:47], v[96:99], v[16:19], v[32:47]
    s_setprio 0
    ds_read_b64_tr_b16 v[24:25], v12 offset:0
    ds_read_b64_tr_b16 v[26:27], v12 offset:1024
    s_add_u32 m0, s24, 8192
    s_add_u32 s26, s70, 114688
    buffer_load_dwordx4 v8, s[44:47], s26 offen lds
    buffer_load_dwordx4 v9, s[44:47], s26 offen offset:1024 lds
    s_setprio 3
    v_mfma_f32_32x32x16_bf16 v[48:63], v[96:99], v[20:23], v[48:63]
    s_setprio 0
    ds_read_b64_tr_b16 v[28:29], v13 offset:0
    ds_read_b64_tr_b16 v[30:31], v13 offset:1024
    s_add_u32 s25, s29, 1024
    buffer_load_dwordx4 v[136:139], v1, s[8:11], s25 offen sc1
    v_mfma_f32_32x32x16_bf16 v[64:79], v[100:103], v[16:19], v[64:79]
    s_xor_b32 s25, s25, 32768
    buffer_load_dwordx4 v[140:143], v1, s[8:11], s25 offen sc1
    s_waitcnt vmcnt(16)
    s_setprio 3
    v_max_u32 v153, v104, v108
    v_cmp_eq_u32 vcc, -1, v153
    s_setprio 0
    s_cbranch_vccnz K_c57_wait
K_c57_ok:
    v_mfma_f32_32x32x16_bf16 v[80:95], v[100:103], v[20:23], v[80:95]
    s_waitcnt lgkmcnt(0)
    s_setprio 3
    v_mfma_f32_32x32x16_bf16 v[32:47], v[104:107], v[24:27], v[32:47]
    s_setprio 0
    ds_read_b64_tr_b16 v[16:17], v12 offset:2048
    ds_read_b64_tr_b16 v[18:19], v12 offset:3072
    s_add_u32 s25, s29, 4096
    buffer_load_dwordx4 v[144:147], v1, s[8:11], s25 offen sc1
    s_setprio 3
    v_mfma_f32_32x32x16_bf16 v[48:63], v[104:107], v[28:31], v[48:63]
    s_setprio 0
    ds_read_b64_tr_b16 v[20:21], v13 offset:2048
    ds_read_b64_tr_b16 v[22:23], v13 offset:3072
    s_xor_b32 s25, s25, 32768
    buffer_load_dwordx4 v[148:151], v1, s[8:11], s25 offen sc1
    v_mfma_f32_32x32x16_bf16 v[64:79], v[108:111], v[24:27], v[64:79]
    s_waitcnt vmcnt(14)
    s_setprio 3
    v_max_u32 v153, v112, v116
    v_cmp_eq_u32 vcc, -1, v153
    s_setprio 0
    s_cbranch_vccnz K_c58_wait
K_c58_ok:
    v_mfma_f32_32x32x16_bf16 v[80:95], v[108:111], v[28:31], v[80:95]
    s_waitcnt lgkmcnt(0)
    s_setprio 3
    v_mfma_f32_32x32x16_bf16 v[32:47], v[112:115], v[16:19], v[32:47]
    s_setprio 0
    ds_read_b64_tr_b16 v[24:25], v12 offset:10240
    ds_read_b64_tr_b16 v[26:27], v12 offset:11264
    s_add_u32 s25, s29, 5120
    buffer_load_dwordx4 v[96:99], v1, s[8:11], s25 offen sc1
    s_setprio 3
    v_mfma_f32_32x32x16_bf16 v[48:63], v[112:115], v[20:23], v[48:63]
    s_setprio 0
    ds_read_b64_tr_b16 v[28:29], v13 offset:10240
    ds_read_b64_tr_b16 v[30:31], v13 offset:11264
    s_xor_b32 s25, s25, 32768
    buffer_load_dwordx4 v[100:103], v1, s[8:11], s25 offen sc1
    v_mfma_f32_32x32x16_bf16 v[64:79], v[116:119], v[16:19], v[64:79]
    s_waitcnt vmcnt(12)
    s_setprio 3
    v_max_u32 v153, v120, v124
    v_cmp_eq_u32 vcc, -1, v153
    s_setprio 0
    s_cbranch_vccnz K_c59_wait
K_c59_ok:
    v_mfma_f32_32x32x16_bf16 v[80:95], v[116:119], v[20:23], v[80:95]
    s_waitcnt lgkmcnt(0)
    s_setprio 3
    v_mfma_f32_32x32x16_bf16 v[32:47], v[120:123], v[24:27], v[32:47]
    s_setprio 0
    ds_read_b64_tr_b16 v[16:17], v14 offset:12288
    ds_read_b64_tr_b16 v[18:19], v14 offset:13312
    s_add_u32 s25, s29, 2048
    buffer_load_dwordx4 v[104:107], v1, s[8:11], s25 offen sc1
    s_setprio 3
    v_mfma_f32_32x32x16_bf16 v[48:63], v[120:123], v[28:31], v[48:63]
    s_setprio 0
    ds_read_b64_tr_b16 v[20:21], v15 offset:12288
    ds_read_b64_tr_b16 v[22:23], v15 offset:13312
    s_xor_b32 s25, s25, 32768
    buffer_load_dwordx4 v[108:111], v1, s[8:11], s25 offen sc1
    v_mfma_f32_32x32x16_bf16 v[64:79], v[124:127], v[24:27], v[64:79]
    s_waitcnt vmcnt(10)
    s_setprio 3
    v_max_u32 v153, v128, v132
    v_cmp_eq_u32 vcc, -1, v153
    s_setprio 0
    s_cbranch_vccnz K_c60_wait
K_c60_ok:
    v_mfma_f32_32x32x16_bf16 v[80:95], v[124:127], v[28:31], v[80:95]
    s_nop 4
    s_setprio 3
    v_sub_f32 v152, 1.0, v152
    v_sub_f32 v154, 1.0, v154
    v_lshlrev_b32 v156, 16, v156
    v_mul_f32 v156, v156, v152
    v_pk_fma_f32 v[32:33], v[32:33], v[152:153], v[156:157] op_sel_hi:[1,0,0]
    v_pk_fma_f32 v[34:35], v[34:35], v[152:153], v[156:157] op_sel_hi:[1,0,0]
    v_pk_fma_f32 v[36:37], v[36:37], v[152:153], v[156:157] op_sel_hi:[1,0,0]
    v_pk_fma_f32 v[38:39], v[38:39], v[152:153], v[156:157] op_sel_hi:[1,0,0]
    v_pk_fma_f32 v[40:41], v[40:41], v[152:153], v[156:157] op_sel_hi:[1,0,0]
    v_pk_fma_f32 v[42:43], v[42:43], v[152:153], v[156:157] op_sel_hi:[1,0,0]
    v_pk_fma_f32 v[44:45], v[44:45], v[152:153], v[156:157] op_sel_hi:[1,0,0]
    v_pk_fma_f32 v[46:47], v[46:47], v[152:153], v[156:157] op_sel_hi:[1,0,0]
    v_pk_mul_f32 v[48:49], v[48:49], v[154:155] op_sel_hi:[1,0]
    v_pk_mul_f32 v[50:51], v[50:51], v[154:155] op_sel_hi:[1,0]
    v_pk_mul_f32 v[52:53], v[52:53], v[154:155] op_sel_hi:[1,0]
    v_pk_mul_f32 v[54:55], v[54:55], v[154:155] op_sel_hi:[1,0]
    v_pk_mul_f32 v[56:57], v[56:57], v[154:155] op_sel_hi:[1,0]
    v_pk_mul_f32 v[58:59], v[58:59], v[154:155] op_sel_hi:[1,0]
    v_pk_mul_f32 v[60:61], v[60:61], v[154:155] op_sel_hi:[1,0]
    v_pk_mul_f32 v[62:63], v[62:63], v[154:155] op_sel_hi:[1,0]
    v_pk_mul_f32 v[64:65], v[64:65], v[152:153] op_sel_hi:[1,0]
    v_pk_mul_f32 v[66:67], v[66:67], v[152:153] op_sel_hi:[1,0]
    v_pk_mul_f32 v[68:69], v[68:69], v[152:153] op_sel_hi:[1,0]
    v_pk_mul_f32 v[70:71], v[70:71], v[152:153] op_sel_hi:[1,0]
    v_pk_mul_f32 v[72:73], v[72:73], v[152:153] op_sel_hi:[1,0]
    v_pk_mul_f32 v[74:75], v[74:75], v[152:153] op_sel_hi:[1,0]
    v_pk_mul_f32 v[76:77], v[76:77], v[152:153] op_sel_hi:[1,0]
    v_pk_mul_f32 v[78:79], v[78:79], v[152:153] op_sel_hi:[1,0]
    v_pk_mul_f32 v[80:81], v[80:81], v[154:155] op_sel_hi:[1,0]
    v_pk_mul_f32 v[82:83], v[82:83], v[154:155] op_sel_hi:[1,0]
    v_pk_mul_f32 v[84:85], v[84:85], v[154:155] op_sel_hi:[1,0]
    v_pk_mul_f32 v[86:87], v[86:87], v[154:155] op_sel_hi:[1,0]
    v_pk_mul_f32 v[88:89], v[88:89], v[154:155] op_sel_hi:[1,0]
    v_pk_mul_f32 v[90:91], v[90:91], v[154:155] op_sel_hi:[1,0]
    v_pk_mul_f32 v[92:93], v[92:93], v[154:155] op_sel_hi:[1,0]
    v_pk_mul_f32 v[94:95], v[94:95], v[154:155] op_sel_hi:[1,0]
    s_setprio 0
    s_waitcnt lgkmcnt(0)
    v_mfma_f32_32x32x16_bf16 v[32:47], v[16:19], v[128:131], v[32:47]
    ds_read_b64_tr_b16 v[24:25], v14 offset:14336
    ds_read_b64_tr_b16 v[26:27], v14 offset:15360
    s_add_u32 s25, s29, 3072
    buffer_load_dwordx4 v[112:115], v1, s[8:11], s25 offen sc1
    v_mfma_f32_32x32x16_bf16 v[48:63], v[16:19], v[132:135], v[48:63]
    ds_read_b64_tr_b16 v[28:29], v15 offset:14336
    ds_read_b64_tr_b16 v[30:31], v15 offset:15360
    s_xor_b32 s25, s25, 32768
    buffer_load_dwordx4 v[116:119], v1, s[8:11], s25 offen sc1
    v_mfma_f32_32x32x16_bf16 v[64:79], v[20:23], v[128:131], v[64:79]
    s_waitcnt vmcnt(8)
    s_setprio 3
    v_max_u32 v153, v136, v140
    v_cmp_eq_u32 vcc, -1, v153
    s_setprio 0
    s_cbranch_vccnz K_c61_wait
K_c61_ok:
    v_mfma_f32_32x32x16_bf16 v[80:95], v[20:23], v[132:135], v[80:95]
    s_waitcnt lgkmcnt(0)
    s_nop 0
    v_mfma_f32_32x32x16_bf16 v[32:47], v[24:27], v[136:139], v[32:47]
    ds_read_b64_tr_b16 v[16:17], v14 offset:16384
    ds_read_b64_tr_b16 v[18:19], v14 offset:17408
    s_add_u32 s25, s29, 6144
    buffer_load_dwordx4 v[120:123], v1, s[8:11], s25 offen sc1
    v_mfma_f32_32x32x16_bf16 v[48:63], v[24:27], v[140:143], v[48:63]
    ds_read_b64_tr_b16 v[20:21], v15 offset:16384
    ds_read_b64_tr_b16 v[22:23], v15 offset:17408
    s_xor_b32 s25, s25, 32768
    buffer_load_dwordx4 v[124:127], v1, s[8:11], s25 offen sc1
    v_mfma_f32_32x32x16_bf16 v[64:79], v[28:31], v[136:139], v[64:79]
    s_waitcnt vmcnt(8)
    s_setprio 3
    v_max_u32 v153, v144, v148
    v_cmp_eq_u32 vcc, -1, v153
    s_setprio 0
    s_cbranch_vccnz K_c62_wait
K_c62_ok:
    v_mfma_f32_32x32x16_bf16 v[80:95], v[28:31], v[140:143], v[80:95]
    s_waitcnt lgkmcnt(0)
    s_nop 0
    v_mfma_f32_32x32x16_bf16 v[32:47], v[16:19], v[144:147], v[32:47]
    ds_read_b64_tr_b16 v[24:25], v14 offset:18432
    ds_read_b64_tr_b16 v[26:27], v14 offset:19456
    s_add_u32 s25, s29, 7168
    buffer_load_dwordx4 v[128:131], v1, s[8:11], s25 offen sc1
    v_mfma_f32_32x32x16_bf16 v[48:63], v[16:19], v[148:151], v[48:63]
    ds_read_b64_tr_b16 v[28:29], v15 offset:18432
    ds_read_b64_tr_b16 v[30:31], v15 offset:19456
    s_xor_b32 s25, s25, 32768
    buffer_load_dwordx4 v[132:135], v1, s[8:11], s25 offen sc1
    v_mfma_f32_32x32x16_bf16 v[64:79], v[20:23], v[144:147], v[64:79]
    s_waitcnt vmcnt(8)
    s_setprio 3
    v_max_u32 v153, v96, v100
    v_cmp_eq_u32 vcc, -1, v153
    s_setprio 0
    s_cbranch_vccnz K_c63_wait
K_c63_ok:
    v_mfma_f32_32x32x16_bf16 v[80:95], v[20:23], v[148:151], v[80:95]
    s_waitcnt lgkmcnt(0)
    s_nop 0
    v_mfma_f32_32x32x16_bf16 v[32:47], v[24:27], v[96:99], v[32:47]
    ds_read_b64_tr_b16 v[16:17], v14 offset:20480
    ds_read_b64_tr_b16 v[18:19], v14 offset:21504
    ds_read_b64_tr_b16 v[20:21], v15 offset:20480
    v_mfma_f32_32x32x16_bf16 v[48:63], v[24:27], v[100:103], v[48:63]
    ds_read_b64_tr_b16 v[22:23], v15 offset:21504
    ds_read_b64_tr_b16 v[136:137], v14 offset:6144
    ds_read_b64_tr_b16 v[138:139], v14 offset:7168
    v_mfma_f32_32x32x16_bf16 v[64:79], v[28:31], v[96:99], v[64:79]
    ds_read_b64_tr_b16 v[140:141], v15 offset:6144
    ds_read_b64_tr_b16 v[142:143], v15 offset:7168
    ds_read_b64_tr_b16 v[144:145], v14 offset:8192
    v_mfma_f32_32x32x16_bf16 v[80:95], v[28:31], v[100:103], v[80:95]
    ds_read_b64_tr_b16 v[146:147], v14 offset:9216
    ds_read_b64_tr_b16 v[148:149], v15 offset:8192
    ds_read_b64_tr_b16 v[150:151], v15 offset:9216
    ds_read_b64_tr_b16 v[24:25], v14 offset:4096
    ds_read_b64_tr_b16 v[26:27], v14 offset:5120
    ds_read_b64_tr_b16 v[28:29], v15 offset:4096
    ds_read_b64_tr_b16 v[30:31], v15 offset:5120
    s_waitcnt vmcnt(0)
    s_setprio 3
    v_max_u32 v153, v104, v108
    v_max3_u32 v153, v153, v112, v116
    v_max3_u32 v153, v153, v120, v124
    v_max3_u32 v153, v153, v128, v132
    v_cmp_eq_u32 vcc, -1, v153
    s_setprio 0
    s_cbranch_vccnz K_c64_wait
K_c64_ok:
    s_waitcnt lgkmcnt(4)
    s_setprio 3
    v_mfma_f32_32x32x16_bf16 v[32:47], v[16:19], v[104:107], v[32:47]
    v_mfma_f32_32x32x16_bf16 v[32:47], v[136:139], v[120:123], v[32:47]
    v_mfma_f32_32x32x16_bf16 v[32:47], v[144:147], v[128:131], v[32:47]
    s_waitcnt lgkmcnt(0)
    v_mfma_f32_32x32x16_bf16 v[32:47], v[24:27], v[112:115], v[32:47]
    v_mfma_f32_32x32x16_bf16 v[48:63], v[16:19], v[108:111], v[48:63]
    s_nop 4
    v_mfma_f32_32x32x16_bf16 v[48:63], v[136:139], v[124:127], v[48:63]
    s_nop 4
    ds_write_b128 v157, v[32:35] offset:0
    ds_write_b128 v157, v[36:39] offset:1088
    v_mfma_f32_32x32x16_bf16 v[48:63], v[144:147], v[132:135], v[48:63]
    ds_write_b128 v157, v[40:43] offset:2176
    ds_write_b128 v157, v[44:47] offset:3264
    v_mfma_f32_32x32x16_bf16 v[48:63], v[24:27], v[116:119], v[48:63]
    v_mfma_f32_32x32x16_bf16 v[64:79], v[20:23], v[104:107], v[64:79]
    s_nop 4
    v_mfma_f32_32x32x16_bf16 v[64:79], v[140:143], v[120:123], v[64:79]
    s_nop 4
    ds_write_b128 v157, v[48:51] offset:4352
    ds_write_b128 v157, v[52:55] offset:5440
    v_mfma_f32_32x32x16_bf16 v[64:79], v[148:151], v[128:131], v[64:79]
    ds_write_b128 v157, v[56:59] offset:6528
    ds_write_b128 v157, v[60:63] offset:7616
    v_mfma_f32_32x32x16_bf16 v[64:79], v[28:31], v[112:115], v[64:79]
    v_mfma_f32_32x32x16_bf16 v[80:95], v[20:23], v[108:111], v[80:95]
    s_nop 4
    v_mfma_f32_32x32x16_bf16 v[80:95], v[140:143], v[124:127], v[80:95]
    s_nop 4
    ds_write_b128 v157, v[64:67] offset:8704
    ds_write_b128 v157, v[68:71] offset:9792
    v_mfma_f32_32x32x16_bf16 v[80:95], v[148:151], v[132:135], v[80:95]
    ds_write_b128 v157, v[72:75] offset:10880
    ds_write_b128 v157, v[76:79] offset:11968
    v_mfma_f32_32x32x16_bf16 v[80:95], v[28:31], v[116:119], v[80:95]
    s_nop 11
    ds_write_b128 v157, v[80:83] offset:13056
    ds_write_b128 v157, v[84:87] offset:14144
    ds_write_b128 v157, v[88:91] offset:15232
    ds_write_b128 v157, v[92:95] offset:16320
    s_waitcnt lgkmcnt(0)
    s_barrier
    ds_read_b128 v[32:35], v163 offset:0
    ds_read_b128 v[36:39], v163 offset:512
    ds_read_b128 v[40:43], v164 offset:4352
    ds_read_b128 v[44:47], v164 offset:4864
    ds_read_b128 v[48:51], v165 offset:8704
    ds_read_b128 v[52:55], v165 offset:9216
    ds_read_b128 v[56:59], v166 offset:13056
    ds_read_b128 v[60:63], v166 offset:13568
    s_add_u32 s33, s72, 16384
    ds_read_b128 v[64:67], v163 offset:256
    ds_read_b128 v[68:71], v163 offset:768
    ds_read_b128 v[72:75], v164 offset:4608
    ds_read_b128 v[76:79], v164 offset:5120
    ds_read_b128 v[80:83], v165 offset:8960
    ds_read_b128 v[84:87], v165 offset:9472
    ds_read_b128 v[88:91], v166 offset:13312
    ds_read_b128 v[92:95], v166 offset:13824
    s_waitcnt lgkmcnt(12)
    v_pk_add_f32 v[32:33], v[32:33], v[40:41]
    v_pk_add_f32 v[34:35], v[34:35], v[42:43]
    v_pk_add_f32 v[36:37], v[36:37], v[44:45]
    v_pk_add_f32 v[38:39], v[38:39], v[46:47]
    s_waitcnt lgkmcnt(10)
    v_pk_add_f32 v[32:33], v[32:33], v[48:49]
    v_pk_add_f32 v[34:35], v[34:35], v[50:51]
    v_pk_add_f32 v[36:37], v[36:37], v[52:53]
    v_pk_add_f32 v[38:39], v[38:39], v[54:55]
    s_waitcnt lgkmcnt(8)
    s_nop 0
    v_pk_add_f32 v[32:33], v[32:33], v[56:57]
    v_pk_add_f32 v[34:35], v[34:35], v[58:59]
    v_pk_add_f32 v[36:37], v[36:37], v[60:61]
    v_pk_add_f32 v[38:39], v[38:39], v[62:63]
    v_cvt_pk_bf16_f32 v16, v32, v33
    v_cvt_pk_bf16_f32 v17, v34, v35
    v_cvt_pk_bf16_f32 v18, v36, v37
    v_cvt_pk_bf16_f32 v19, v38, v39
    buffer_store_dwordx4 v[16:19], v159, s[52:55], s72 offen
    s_waitcnt lgkmcnt(4)
    v_pk_add_f32 v[64:65], v[64:65], v[72:73]
    v_pk_add_f32 v[66:67], v[66:67], v[74:75]
    v_pk_add_f32 v[68:69], v[68:69], v[76:77]
    v_pk_add_f32 v[70:71], v[70:71], v[78:79]
    s_waitcnt lgkmcnt(2)
    v_pk_add_f32 v[64:65], v[64:65], v[80:81]
    v_pk_add_f32 v[66:67], v[66:67], v[82:83]
    v_pk_add_f32 v[68:69], v[68:69], v[84:85]
    v_pk_add_f32 v[70:71], v[70:71], v[86:87]
    s_waitcnt lgkmcnt(0)
    s_nop 0
    v_pk_add_f32 v[64:65], v[64:65], v[88:89]
    v_pk_add_f32 v[66:67], v[66:67], v[90:91]
    v_pk_add_f32 v[68:69], v[68:69], v[92:93]
    v_pk_add_f32 v[70:71], v[70:71], v[94:95]
    v_cvt_pk_bf16_f32 v20, v64, v65
    v_cvt_pk_bf16_f32 v21, v66, v67
    v_cvt_pk_bf16_f32 v22, v68, v69
    v_cvt_pk_bf16_f32 v23, v70, v71
    buffer_store_dwordx4 v[20:23], v159, s[52:55], s33 offen
K_end:
    s_endpgm
K_jit2:
    buffer_load_dword v167, v167, s[12:15], s3 offen
    s_branch K_jitr2
K_jit3:
    buffer_load_dword v167, v167, s[12:15], s3 offen
    s_branch K_jitr3
K_jit4:
    buffer_load_dword v167, v167, s[12:15], s3 offen
    s_branch K_jitr4
K_jit5:
    buffer_load_dword v167, v167, s[12:15], s3 offen
    s_branch K_jitr5
K_jit6:
    buffer_load_dword v167, v167, s[12:15], s3 offen
    s_branch K_jitr6
K_jit7:
    buffer_load_dword v167, v167, s[12:15], s3 offen
    s_branch K_jitr7
K_jit8:
    buffer_load_dword v167, v167, s[12:15], s3 offen
    s_branch K_jitr8
K_jit9:
    buffer_load_dword v167, v167, s[12:15], s3 offen
    s_branch K_jitr9
K_jit10:
    buffer_load_dword v167, v167, s[12:15], s3 offen
    s_branch K_jitr10
K_jit11:
    buffer_load_dword v167, v167, s[12:15], s3 offen
    s_branch K_jitr11
K_jit12:
    buffer_load_dword v167, v167, s[12:15], s3 offen
    s_branch K_jitr12
K_jit13:
    buffer_load_dword v167, v167, s[12:15], s3 offen
    s_branch K_jitr13
K_jit14:
    buffer_load_dword v167, v167, s[12:15], s3 offen
    s_branch K_jitr14
K_jit15:
    buffer_load_dword v167, v167, s[12:15], s3 offen
    s_branch K_jitr15
K_jit16:
    buffer_load_dword v167, v167, s[12:15], s3 offen
    s_branch K_jitr16
K_jit17:
    buffer_load_dword v167, v167, s[12:15], s3 offen
    s_branch K_jitr17
K_jit18:
    buffer_load_dword v167, v167, s[12:15], s3 offen
    s_branch K_jitr18
K_jit19:
    buffer_load_dword v167, v167, s[12:15], s3 offen
    s_branch K_jitr19
K_jit20:
    buffer_load_dword v167, v167, s[12:15], s3 offen
    s_branch K_jitr20
K_jit21:
    buffer_load_dword v167, v167, s[12:15], s3 offen
    s_branch K_jitr21
K_c32_wait:
K_c32_retry:
    s_cmp_eq_u32 s60, 0
    s_cbranch_scc1 K_c32_ok
    s_sub_u32 s60, s60, 1
    s_sleep 2
    s_add_u32 s25, s28, 0
    buffer_load_dwordx4 v[128:131], v1, s[8:11], s25 offen sc1
    s_add_u32 s25, s25, s23
    buffer_load_dwordx4 v[132:135], v1, s[8:11], s25 offen sc1
    s_add_u32 s25, s28, 1024
    buffer_load_dwordx4 v[136:139], v1, s[8:11], s25 offen sc1
    s_add_u32 s25, s25, s23
    buffer_load_dwordx4 v[140:143], v1, s[8:11], s25 offen sc1
    s_add_u32 s25, s28, 2048
    buffer_load_dwordx4 v[144:147], v1, s[8:11], s25 offen sc1
    s_add_u32 s25, s25, s23
    buffer_load_dwordx4 v[148:151], v1, s[8:11], s25 offen sc1
    s_add_u32 s25, s28, 3072
    buffer_load_dwordx4 v[96:99], v1, s[8:11], s25 offen sc1
    s_add_u32 s25, s25, s23
    buffer_load_dwordx4 v[100:103], v1, s[8:11], s25 offen sc1
    s_waitcnt vmcnt(0)
    s_setprio 3
    v_max_u32 v153, v128, v132
    v_cmp_eq_u32 vcc, -1, v153
    s_setprio 0
    s_cbranch_vccnz K_c32_retry
    s_branch K_c32_ok
K_c33_wait:
K_c33_retry:
    s_cmp_eq_u32 s60, 0
    s_cbranch_scc1 K_c33_ok
    s_sub_u32 s60, s60, 1
    s_sleep 2
    s_add_u32 s25, s28, 1024
    buffer_load_dwordx4 v[136:139], v1, s[8:11], s25 offen sc1
    s_add_u32 s25, s25, s23
    buffer_load_dwordx4 v[140:143], v1, s[8:11], s25 offen sc1
    s_add_u32 s25, s28, 2048
    buffer_load_dwordx4 v[144:147], v1, s[8:11], s25 offen sc1
    s_add_u32 s25, s25, s23
    buffer_load_dwordx4 v[148:151], v1, s[8:11], s25 offen sc1
    s_add_u32 s25, s28, 3072
    buffer_load_dwordx4 v[96:99], v1, s[8:11], s25 offen sc1
    s_add_u32 s25, s25, s23
    buffer_load_dwordx4 v[100:103], v1, s[8:11], s25 offen sc1
    s_waitcnt vmcnt(0)
    s_setprio 3
    v_max_u32 v153, v136, v140
    v_cmp_eq_u32 vcc, -1, v153
    s_setprio 0
    s_cbranch_vccnz K_c33_retry
    s_branch K_c33_ok
K_c34_wait:
K_c34_retry:
    s_cmp_eq_u32 s60, 0
    s_cbranch_scc1 K_c34_ok
    s_sub_u32 s60, s60, 1
    s_sleep 2
    s_add_u32 s25, s28, 2048
    buffer_load_dwordx4 v[144:147], v1, s[8:11], s25 offen sc1
    s_add_u32 s25, s25, s23
    buffer_load_dwordx4 v[148:151], v1, s[8:11], s25 offen sc1
    s_add_u32 s25, s28, 3072
    buffer_load_dwordx4 v[96:99], v1, s[8:11], s25 offen sc1
    s_add_u32 s25, s25, s23
    buffer_load_dwordx4 v[100:103], v1, s[8:11], s25 offen sc1
    s_waitcnt vmcnt(0)
    s_setprio 3
    v_max_u32 v153, v144, v148
    v_cmp_eq_u32 vcc, -1, v153
    s_setprio 0
    s_cbranch_vccnz K_c34_retry
    s_branch K_c34_ok
K_c35_wait:
K_c35_retry:
    s_cmp_eq_u32 s60, 0
    s_cbranch_scc1 K_c35_ok
    s_sub_u32 s60, s60, 1
    s_sleep 2
    s_add_u32 s25, s28, 3072
    buffer_load_dwordx4 v[96:99], v1, s[8:11], s25 offen sc1
    s_add_u32 s25, s25, s23
    buffer_load_dwordx4 v[100:103], v1, s[8:11], s25 offen sc1
    s_waitcnt vmcnt(0)
    s_setprio 3
    v_max_u32 v153, v96, v100
    v_cmp_eq_u32 vcc, -1, v153
    s_setprio 0
    s_cbranch_vccnz K_c35_retry
    s_branch K_c35_ok
K_c36_wait:
K_c36_retry:
    s_cmp_eq_u32 s60, 0
    s_cbranch_scc1 K_c36_ok
    s_sub_u32 s60, s60, 1
    s_sleep 2
    s_add_u32 s25, s28, 4096
    buffer_load_dwordx4 v[104:107], v1, s[8:11], s25 offen sc1
    s_add_u32 s25, s25, s23
    buffer_load_dwordx4 v[108:111], v1, s[8:11], s25 offen sc1
    s_add_u32 s25, s28, 5120
    buffer_load_dwordx4 v[112:115], v1, s[8:11], s25 offen sc1
    s_add_u32 s25, s25, s23
    buffer_load_dwordx4 v[116:119], v1, s[8:11], s25 offen sc1
    s_add_u32 s25, s28, 6144
    buffer_load_dwordx4 v[120:123], v1, s[8:11], s25 offen sc1
    s_add_u32 s25, s25, s23
    buffer_load_dwordx4 v[124:127], v1, s[8:11], s25 offen sc1
    s_add_u32 s25, s28, 7168
    buffer_load_dwordx4 v[128:131], v1, s[8:11], s25 offen sc1
    s_add_u32 s25, s25, s23
    buffer_load_dwordx4 v[132:135], v1, s[8:11], s25 offen sc1
    s_waitcnt vmcnt(0)
    s_setprio 3
    v_max_u32 v153, v104, v108
    v_cmp_eq_u32 vcc, -1, v153
    s_setprio 0
    s_cbranch_vccnz K_c36_retry
    s_branch K_c36_ok
K_c37_wait:
K_c37_retry:
    s_cmp_eq_u32 s60, 0
    s_cbranch_scc1 K_c37_ok
    s_sub_u32 s60, s60, 1
    s_sleep 2
    s_add_u32 s25, s28, 5120
    buffer_load_dwordx4 v[112:115], v1, s[8:11], s25 offen sc1
    s_add_u32 s25, s25, s23
    buffer_load_dwordx4 v[116:119], v1, s[8:11], s25 offen sc1
    s_add_u32 s25, s28, 6144
    buffer_load_dwordx4 v[120:123], v1, s[8:11], s25 offen sc1
    s_add_u32 s25, s25, s23
    buffer_load_dwordx4 v[124:127], v1, s[8:11], s25 offen sc1
    s_add_u32 s25, s28, 7168
    buffer_load_dwordx4 v[128:131], v1, s[8:11], s25 offen sc1
    s_add_u32 s25, s25, s23
    buffer_load_dwordx4 v[132:135], v1, s[8:11], s25 offen sc1
    s_waitcnt vmcnt(0)
    s_setprio 3
    v_max_u32 v153, v112, v116
    v_cmp_eq_u32 vcc, -1, v153
    s_setprio 0
    s_cbranch_vccnz K_c37_retry
    s_branch K_c37_ok
K_c38_wait:
K_c38_retry:
    s_cmp_eq_u32 s60, 0
    s_cbranch_scc1 K_c38_ok
    s_sub_u32 s60, s60, 1
    s_sleep 2
    s_add_u32 s25, s28, 6144
    buffer_load_dwordx4 v[120:123], v1, s[8:11], s25 offen sc1
    s_add_u32 s25, s25, s23
    buffer_load_dwordx4 v[124:127], v1, s[8:11], s25 offen sc1
    s_add_u32 s25, s28, 7168
    buffer_load_dwordx4 v[128:131], v1, s[8:11], s25 offen sc1
    s_add_u32 s25, s25, s23
    buffer_load_dwordx4 v[132:135], v1, s[8:11], s25 offen sc1
    s_waitcnt vmcnt(0)
    s_setprio 3
    v_max_u32 v153, v120, v124
    v_cmp_eq_u32 vcc, -1, v153
    s_setprio 0
    s_cbranch_vccnz K_c38_retry
    s_branch K_c38_ok
K_c39_wait:
K_c39_retry:
    s_cmp_eq_u32 s60, 0
    s_cbranch_scc1 K_c39_ok
    s_sub_u32 s60, s60, 1
    s_sleep 2
    s_add_u32 s25, s28, 7168
    buffer_load_dwordx4 v[128:131], v1, s[8:11], s25 offen sc1
    s_add_u32 s25, s25, s23
    buffer_load_dwordx4 v[132:135], v1, s[8:11], s25 offen sc1
    s_waitcnt vmcnt(0)
    s_setprio 3
    v_max_u32 v153, v128, v132
    v_cmp_eq_u32 vcc, -1, v153
    s_setprio 0
    s_cbranch_vccnz K_c39_retry
    s_branch K_c39_ok
K_c40_wait:
K_c40_retry:
    s_cmp_eq_u32 s60, 0
    s_cbranch_scc1 K_c40_ok
    s_sub_u32 s60, s60, 1
    s_sleep 2
    s_add_u32 s25, s28, 8192
    buffer_load_dwordx4 v[136:139], v1, s[8:11], s25 offen sc1
    s_add_u32 s25, s25, s23
    buffer_load_dwordx4 v[140:143], v1, s[8:11], s25 offen sc1
    s_add_u32 s25, s28, 9216
    buffer_load_dwordx4 v[144:147], v1, s[8:11], s25 offen sc1
    s_add_u32 s25, s25, s23
    buffer_load_dwordx4 v[148:151], v1, s[8:11], s25 offen sc1
    s_add_u32 s25, s28, 10240
    buffer_load_dwordx4 v[96:99], v1, s[8:11], s25 offen sc1
    s_add_u32 s25, s25, s23
    buffer_load_dwordx4 v[100:103], v1, s[8:11], s25 offen sc1
    s_add_u32 s25, s28, 11264
    buffer_load_dwordx4 v[104:107], v1, s[8:11], s25 offen sc1
    s_add_u32 s25, s25, s23
    buffer_load_dwordx4 v[108:111], v1, s[8:11], s25 offen sc1
    s_waitcnt vmcnt(0)
    s_setprio 3
    v_max_u32 v153, v136, v140
    v_cmp_eq_u32 vcc, -1, v153
    s_setprio 0
    s_cbranch_vccnz K_c40_retry
    s_branch K_c40_ok
K_c41_wait:
K_c41_retry:
    s_cmp_eq_u32 s60, 0
    s_cbranch_scc1 K_c41_ok
    s_sub_u32 s60, s60, 1
    s_sleep 2
    s_add_u32 s25, s28, 9216
    buffer_load_dwordx4 v[144:147], v1, s[8:11], s25 offen sc1
    s_add_u32 s25, s25, s23
    buffer_load_dwordx4 v[148:151], v1, s[8:11], s25 offen sc1
    s_add_u32 s25, s28, 10240
    buffer_load_dwordx4 v[96:99], v1, s[8:11], s25 offen sc1
    s_add_u32 s25, s25, s23
    buffer_load_dwordx4 v[100:103], v1, s[8:11], s25 offen sc1
    s_add_u32 s25, s28, 11264
    buffer_load_dwordx4 v[104:107], v1, s[8:11], s25 offen sc1
    s_add_u32 s25, s25, s23
    buffer_load_dwordx4 v[108:111], v1, s[8:11], s25 offen sc1
    s_waitcnt vmcnt(0)
    s_setprio 3
    v_max_u32 v153, v144, v148
    v_cmp_eq_u32 vcc, -1, v153
    s_setprio 0
    s_cbranch_vccnz K_c41_retry
    s_branch K_c41_ok
K_c42_wait:
K_c42_retry:
    s_cmp_eq_u32 s60, 0
    s_cbranch_scc1 K_c42_ok
    s_sub_u32 s60, s60, 1
    s_sleep 2
    s_add_u32 s25, s28, 10240
    buffer_load_dwordx4 v[96:99], v1, s[8:11], s25 offen sc1
    s_add_u32 s25, s25, s23
    buffer_load_dwordx4 v[100:103], v1, s[8:11], s25 offen sc1
    s_add_u32 s25, s28, 11264
    buffer_load_dwordx4 v[104:107], v1, s[8:11], s25 offen sc1
    s_add_u32 s25, s25, s23
    buffer_load_dwordx4 v[108:111], v1, s[8:11], s25 offen sc1
    s_waitcnt vmcnt(0)
    s_setprio 3
    v_max_u32 v153, v96, v100
    v_cmp_eq_u32 vcc, -1, v153
    s_setprio 0
    s_cbranch_vccnz K_c42_retry
    s_branch K_c42_ok
K_c43_wait:
K_c43_retry:
    s_cmp_eq_u32 s60, 0
    s_cbranch_scc1 K_c43_ok
    s_sub_u32 s60, s60, 1
    s_sleep 2
    s_add_u32 s25, s28, 11264
    buffer_load_dwordx4 v[104:107], v1, s[8:11], s25 offen sc1
    s_add_u32 s25, s25, s23
    buffer_load_dwordx4 v[108:111], v1, s[8:11], s25 offen sc1
    s_waitcnt vmcnt(0)
    s_setprio 3
    v_max_u32 v153, v104, v108
    v_cmp_eq_u32 vcc, -1, v153
    s_setprio 0
    s_cbranch_vccnz K_c43_retry
    s_branch K_c43_ok
K_c44_wait:
K_c44_retry:
    s_cmp_eq_u32 s60, 0
    s_cbranch_scc1 K_c44_ok
    s_sub_u32 s60, s60, 1
    s_sleep 2
    s_add_u32 s25, s28, 12288
    buffer_load_dwordx4 v[112:115], v1, s[8:11], s25 offen sc1
    s_add_u32 s25, s25, s23
    buffer_load_dwordx4 v[116:119], v1, s[8:11], s25 offen sc1
    s_add_u32 s25, s28, 13312
    buffer_load_dwordx4 v[120:123], v1, s[8:11], s25 offen sc1
    s_add_u32 s25, s25, s23
    buffer_load_dwordx4 v[124:127], v1, s[8:11], s25 offen sc1
    s_add_u32 s25, s28, 14336
    buffer_load_dwordx4 v[128:131], v1, s[8:11], s25 offen sc1
    s_add_u32 s25, s25, s23
    buffer_load_dwordx4 v[132:135], v1, s[8:11], s25 offen sc1
    s_add_u32 s25, s28, 15360
    buffer_load_dwordx4 v[136:139], v1, s[8:11], s25 offen sc1
    s_add_u32 s25, s25, s23
    buffer_load_dwordx4 v[140:143], v1, s[8:11], s25 offen sc1
    s_waitcnt vmcnt(0)
    s_setprio 3
    v_max_u32 v153, v112, v116
    v_cmp_eq_u32 vcc, -1, v153
    s_setprio 0
    s_cbranch_vccnz K_c44_retry
    s_branch K_c44_ok
K_c45_wait:
K_c45_retry:
    s_cmp_eq_u32 s60, 0
    s_cbranch_scc1 K_c45_ok
    s_sub_u32 s60, s60, 1
    s_sleep 2
    s_add_u32 s25, s28, 13312
    buffer_load_dwordx4 v[120:123], v1, s[8:11], s25 offen sc1
    s_add_u32 s25, s25, s23
    buffer_load_dwordx4 v[124:127], v1, s[8:11], s25 offen sc1
    s_add_u32 s25, s28, 14336
    buffer_load_dwordx4 v[128:131], v1, s[8:11], s25 offen sc1
    s_add_u32 s25, s25, s23
    buffer_load_dwordx4 v[132:135], v1, s[8:11], s25 offen sc1
    s_add_u32 s25, s28, 15360
    buffer_load_dwordx4 v[136:139], v1, s[8:11], s25 offen sc1
    s_add_u32 s25, s25, s23
    buffer_load_dwordx4 v[140:143], v1, s[8:11], s25 offen sc1
    s_waitcnt vmcnt(0)
    s_setprio 3
    v_max_u32 v153, v120, v124
    v_cmp_eq_u32 vcc, -1, v153
    s_setprio 0
    s_cbranch_vccnz K_c45_retry
    s_branch K_c45_ok
K_c46_wait:
K_c46_retry:
    s_cmp_eq_u32 s60, 0
    s_cbranch_scc1 K_c46_ok
    s_sub_u32 s60, s60, 1
    s_sleep 2
    s_add_u32 s25, s28, 14336
    buffer_load_dwordx4 v[128:131], v1, s[8:11], s25 offen sc1
    s_add_u32 s25, s25, s23
    buffer_load_dwordx4 v[132:135], v1, s[8:11], s25 offen sc1
    s_add_u32 s25, s28, 15360
    buffer_load_dwordx4 v[136:139], v1, s[8:11], s25 offen sc1
    s_add_u32 s25, s25, s23
    buffer_load_dwordx4 v[140:143], v1, s[8:11], s25 offen sc1
    s_waitcnt vmcnt(0)
    s_setprio 3
    v_max_u32 v153, v128, v132
    v_cmp_eq_u32 vcc, -1, v153
    s_setprio 0
    s_cbranch_vccnz K_c46_retry
    s_branch K_c46_ok
K_c47_wait:
K_c47_retry:
    s_cmp_eq_u32 s60, 0
    s_cbranch_scc1 K_c47_ok
    s_sub_u32 s60, s60, 1
    s_sleep 2
    s_add_u32 s25, s28, 15360
    buffer_load_dwordx4 v[136:139], v1, s[8:11], s25 offen sc1
    s_add_u32 s25, s25, s23
    buffer_load_dwordx4 v[140:143], v1, s[8:11], s25 offen sc1
    s_waitcnt vmcnt(0)
    s_setprio 3
    v_max_u32 v153, v136, v140
    v_cmp_eq_u32 vcc, -1, v153
    s_setprio 0
    s_cbranch_vccnz K_c47_retry
    s_branch K_c47_ok
K_c48_wait:
K_c48_retry:
    s_cmp_eq_u32 s60, 0
    s_cbranch_scc1 K_c48_ok
    s_sub_u32 s60, s60, 1
    s_sleep 2
    s_add_u32 s25, s28, 16384
    buffer_load_dwordx4 v[144:147], v1, s[8:11], s25 offen sc1
    s_add_u32 s25, s25, s23
    buffer_load_dwordx4 v[148:151], v1, s[8:11], s25 offen sc1
    s_add_u32 s25, s28, 17408
    buffer_load_dwordx4 v[96:99], v1, s[8:11], s25 offen sc1
    s_add_u32 s25, s25, s23
    buffer_load_dwordx4 v[100:103], v1, s[8:11], s25 offen sc1
    s_add_u32 s25, s28, 18432
    buffer_load_dwordx4 v[104:107], v1, s[8:11], s25 offen sc1
    s_add_u32 s25, s25, s23
    buffer_load_dwordx4 v[108:111], v1, s[8:11], s25 offen sc1
    s_add_u32 s25, s28, 19456
    buffer_load_dwordx4 v[112:115], v1, s[8:11], s25 offen sc1
    s_add_u32 s25, s25, s23
    buffer_load_dwordx4 v[116:119], v1, s[8:11], s25 offen sc1
    s_waitcnt vmcnt(0)
    s_setprio 3
    v_max_u32 v153, v144, v148
    v_cmp_eq_u32 vcc, -1, v153
    s_setprio 0
    s_cbranch_vccnz K_c48_retry
    s_branch K_c48_ok
K_c49_wait:
K_c49_retry:
    s_cmp_eq_u32 s60, 0
    s_cbranch_scc1 K_c49_ok
    s_sub_u32 s60, s60, 1
    s_sleep 2
    s_add_u32 s25, s28, 17408
    buffer_load_dwordx4 v[96:99], v1, s[8:11], s25 offen sc1
    s_add_u32 s25, s25, s23
    buffer_load_dwordx4 v[100:103], v1, s[8:11], s25 offen sc1
    s_add_u32 s25, s28, 18432
    buffer_load_dwordx4 v[104:107], v1, s[8:11], s25 offen sc1
    s_add_u32 s25, s25, s23
    buffer_load_dwordx4 v[108:111], v1, s[8:11], s25 offen sc1
    s_add_u32 s25, s28, 19456
    buffer_load_dwordx4 v[112:115], v1, s[8:11], s25 offen sc1
    s_add_u32 s25, s25, s23
    buffer_load_dwordx4 v[116:119], v1, s[8:11], s25 offen sc1
    s_waitcnt vmcnt(0)
    s_setprio 3
    v_max_u32 v153, v96, v100
    v_cmp_eq_u32 vcc, -1, v153
    s_setprio 0
    s_cbranch_vccnz K_c49_retry
    s_branch K_c49_ok
K_c50_wait:
K_c50_retry:
    s_cmp_eq_u32 s60, 0
    s_cbranch_scc1 K_c50_ok
    s_sub_u32 s60, s60, 1
    s_sleep 2
    s_add_u32 s25, s28, 18432
    buffer_load_dwordx4 v[104:107], v1, s[8:11], s25 offen sc1
    s_add_u32 s25, s25, s23
    buffer_load_dwordx4 v[108:111], v1, s[8:11], s25 offen sc1
    s_add_u32 s25, s28, 19456
    buffer_load_dwordx4 v[112:115], v1, s[8:11], s25 offen sc1
    s_add_u32 s25, s25, s23
    buffer_load_dwordx4 v[116:119], v1, s[8:11], s25 offen sc1
    s_waitcnt vmcnt(0)
    s_setprio 3
    v_max_u32 v153, v104, v108
    v_cmp_eq_u32 vcc, -1, v153
    s_setprio 0
    s_cbranch_vccnz K_c50_retry
    s_branch K_c50_ok
K_c51_wait:
K_c51_retry:
    s_cmp_eq_u32 s60, 0
    s_cbranch_scc1 K_c51_ok
    s_sub_u32 s60, s60, 1
    s_sleep 2
    s_add_u32 s25, s28, 19456
    buffer_load_dwordx4 v[112:115], v1, s[8:11], s25 offen sc1
    s_add_u32 s25, s25, s23
    buffer_load_dwordx4 v[116:119], v1, s[8:11], s25 offen sc1
    s_waitcnt vmcnt(0)
    s_setprio 3
    v_max_u32 v153, v112, v116
    v_cmp_eq_u32 vcc, -1, v153
    s_setprio 0
    s_cbranch_vccnz K_c51_retry
    s_branch K_c51_ok
K_c52_wait:
K_c52_retry:
    s_cmp_eq_u32 s60, 0
    s_cbranch_scc1 K_c52_ok
    s_sub_u32 s60, s60, 1
    s_sleep 2
    s_add_u32 s25, s28, 20480
    buffer_load_dwordx4 v[120:123], v1, s[8:11], s25 offen sc1
    s_add_u32 s25, s25, s23
    buffer_load_dwordx4 v[124:127], v1, s[8:11], s25 offen sc1
    s_add_u32 s25, s28, 21504
    buffer_load_dwordx4 v[128:131], v1, s[8:11], s25 offen sc1
    s_add_u32 s25, s25, s23
    buffer_load_dwordx4 v[132:135], v1, s[8:11], s25 offen sc1
    s_add_u32 s25, s28, 22528
    buffer_load_dwordx4 v[136:139], v1, s[8:11], s25 offen sc1
    s_add_u32 s25, s25, s23
    buffer_load_dwordx4 v[140:143], v1, s[8:11], s25 offen sc1
    s_add_u32 s25, s28, 23552
    buffer_load_dwordx4 v[144:147], v1, s[8:11], s25 offen sc1
    s_add_u32 s25, s25, s23
    buffer_load_dwordx4 v[148:151], v1, s[8:11], s25 offen sc1
    s_waitcnt vmcnt(0)
    s_setprio 3
    v_max_u32 v153, v120, v124
    v_cmp_eq_u32 vcc, -1, v153
    s_setprio 0
    s_cbranch_vccnz K_c52_retry
    s_branch K_c52_ok
K_c53_wait:
K_c53_retry:
    s_cmp_eq_u32 s60, 0
    s_cbranch_scc1 K_c53_ok
    s_sub_u32 s60, s60, 1
    s_sleep 2
    s_add_u32 s25, s28, 21504
    buffer_load_dwordx4 v[128:131], v1, s[8:11], s25 offen sc1
    s_add_u32 s25, s25, s23
    buffer_load_dwordx4 v[132:135], v1, s[8:11], s25 offen sc1
    s_add_u32 s25, s28, 22528
    buffer_load_dwordx4 v[136:139], v1, s[8:11], s25 offen sc1
    s_add_u32 s25, s25, s23
    buffer_load_dwordx4 v[140:143], v1, s[8:11], s25 offen sc1
    s_add_u32 s25, s28, 23552
    buffer_load_dwordx4 v[144:147], v1, s[8:11], s25 offen sc1
    s_add_u32 s25, s25, s23
    buffer_load_dwordx4 v[148:151], v1, s[8:11], s25 offen sc1
    s_waitcnt vmcnt(0)
    s_setprio 3
    v_max_u32 v153, v128, v132
    v_cmp_eq_u32 vcc, -1, v153
    s_setprio 0
    s_cbranch_vccnz K_c53_retry
    s_branch K_c53_ok
K_c54_wait:
K_c54_retry:
    s_cmp_eq_u32 s60, 0
    s_cbranch_scc1 K_c54_ok
    s_sub_u32 s60, s60, 1
    s_sleep 2
    s_add_u32 s25, s28, 22528
    buffer_load_dwordx4 v[136:139], v1, s[8:11], s25 offen sc1
    s_add_u32 s25, s25, s23
    buffer_load_dwordx4 v[140:143], v1, s[8:11], s25 offen sc1
    s_add_u32 s25, s28, 23552
    buffer_load_dwordx4 v[144:147], v1, s[8:11], s25 offen sc1
    s_add_u32 s25, s25, s23
    buffer_load_dwordx4 v[148:151], v1, s[8:11], s25 offen sc1
    s_waitcnt vmcnt(0)
    s_setprio 3
    v_max_u32 v153, v136, v140
    v_cmp_eq_u32 vcc, -1, v153
    s_setprio 0
    s_cbranch_vccnz K_c54_retry
    s_branch K_c54_ok
K_c55_wait:
K_c55_retry:
    s_cmp_eq_u32 s60, 0
    s_cbranch_scc1 K_c55_ok
    s_sub_u32 s60, s60, 1
    s_sleep 2
    s_add_u32 s25, s28, 23552
    buffer_load_dwordx4 v[144:147], v1, s[8:11], s25 offen sc1
    s_add_u32 s25, s25, s23
    buffer_load_dwordx4 v[148:151], v1, s[8:11], s25 offen sc1
    s_waitcnt vmcnt(0)
    s_setprio 3
    v_max_u32 v153, v144, v148
    v_cmp_eq_u32 vcc, -1, v153
    s_setprio 0
    s_cbranch_vccnz K_c55_retry
    s_branch K_c55_ok
K_c56_wait:
K_c56_retry:
    s_cmp_eq_u32 s60, 0
    s_cbranch_scc1 K_c56_ok
    s_sub_u32 s60, s60, 1
    s_sleep 2
    s_add_u32 s25, s28, 24576
    buffer_load_dwordx4 v[96:99], v1, s[8:11], s25 offen sc1
    s_add_u32 s25, s25, s23
    buffer_load_dwordx4 v[100:103], v1, s[8:11], s25 offen sc1
    s_add_u32 s25, s28, 25600
    buffer_load_dwordx4 v[104:107], v1, s[8:11], s25 offen sc1
    s_add_u32 s25, s25, s23
    buffer_load_dwordx4 v[108:111], v1, s[8:11], s25 offen sc1
    s_add_u32 s25, s28, 26624
    buffer_load_dwordx4 v[112:115], v1, s[8:11], s25 offen sc1
    s_add_u32 s25, s25, s23
    buffer_load_dwordx4 v[116:119], v1, s[8:11], s25 offen sc1
    s_add_u32 s25, s28, 27648
    buffer_load_dwordx4 v[120:123], v1, s[8:11], s25 offen sc1
    s_add_u32 s25, s25, s23
    buffer_load_dwordx4 v[124:127], v1, s[8:11], s25 offen sc1
    s_waitcnt vmcnt(0)
    s_setprio 3
    v_max_u32 v153, v96, v100
    v_cmp_eq_u32 vcc, -1, v153
    s_setprio 0
    s_cbranch_vccnz K_c56_retry
    s_branch K_c56_ok
K_c57_wait:
K_c57_retry:
    s_cmp_eq_u32 s60, 0
    s_cbranch_scc1 K_c57_ok
    s_sub_u32 s60, s60, 1
    s_sleep 2
    s_add_u32 s25, s28, 25600
    buffer_load_dwordx4 v[104:107], v1, s[8:11], s25 offen sc1
    s_add_u32 s25, s25, s23
    buffer_load_dwordx4 v[108:111], v1, s[8:11], s25 offen sc1
    s_add_u32 s25, s28, 26624
    buffer_load_dwordx4 v[112:115], v1, s[8:11], s25 offen sc1
    s_add_u32 s25, s25, s23
    buffer_load_dwordx4 v[116:119], v1, s[8:11], s25 offen sc1
    s_add_u32 s25, s28, 27648
    buffer_load_dwordx4 v[120:123], v1, s[8:11], s25 offen sc1
    s_add_u32 s25, s25, s23
    buffer_load_dwordx4 v[124:127], v1, s[8:11], s25 offen sc1
    s_waitcnt vmcnt(0)
    s_setprio 3
    v_max_u32 v153, v104, v108
    v_cmp_eq_u32 vcc, -1, v153
    s_setprio 0
    s_cbranch_vccnz K_c57_retry
    s_branch K_c57_ok
K_c58_wait:
K_c58_retry:
    s_cmp_eq_u32 s60, 0
    s_cbranch_scc1 K_c58_ok
    s_sub_u32 s60, s60, 1
    s_sleep 2
    s_add_u32 s25, s28, 26624
    buffer_load_dwordx4 v[112:115], v1, s[8:11], s25 offen sc1
    s_add_u32 s25, s25, s23
    buffer_load_dwordx4 v[116:119], v1, s[8:11], s25 offen sc1
    s_add_u32 s25, s28, 27648
    buffer_load_dwordx4 v[120:123], v1, s[8:11], s25 offen sc1
    s_add_u32 s25, s25, s23
    buffer_load_dwordx4 v[124:127], v1, s[8:11], s25 offen sc1
    s_waitcnt vmcnt(0)
    s_setprio 3
    v_max_u32 v153, v112, v116
    v_cmp_eq_u32 vcc, -1, v153
    s_setprio 0
    s_cbranch_vccnz K_c58_retry
    s_branch K_c58_ok
K_c59_wait:
K_c59_retry:
    s_cmp_eq_u32 s60, 0
    s_cbranch_scc1 K_c59_ok
    s_sub_u32 s60, s60, 1
    s_sleep 2
    s_add_u32 s25, s28, 27648
    buffer_load_dwordx4 v[120:123], v1, s[8:11], s25 offen sc1
    s_add_u32 s25, s25, s23
    buffer_load_dwordx4 v[124:127], v1, s[8:11], s25 offen sc1
    s_waitcnt vmcnt(0)
    s_setprio 3
    v_max_u32 v153, v120, v124
    v_cmp_eq_u32 vcc, -1, v153
    s_setprio 0
    s_cbranch_vccnz K_c59_retry
    s_branch K_c59_ok
K_c60_wait:
    s_setprio 3
K_c60_sp:
    ds_read_b32 v153, v2 offset:16
    s_waitcnt lgkmcnt(0)
    v_readfirstlane_b32 s33, v153
    s_cmp_ge_u32 s33, 4
    s_cbranch_scc1 K_c60_sp_ok
    s_sleep 1
    s_branch K_c60_sp
K_c60_sp_ok:
    s_setprio 0
K_c60_retry:
    s_cmp_eq_u32 s60, 0
    s_cbranch_scc1 K_c60_ok
    s_sub_u32 s60, s60, 1
    s_sleep 2
    s_add_u32 s25, s29, 0
    s_nop 0
    buffer_load_dwordx4 v[128:131], v1, s[8:11], s25 offen sc1
    s_xor_b32 s25, s25, 32768
    buffer_load_dwordx4 v[132:135], v1, s[8:11], s25 offen sc1
    s_add_u32 s25, s29, 1024
    buffer_load_dwordx4 v[136:139], v1, s[8:11], s25 offen sc1
    s_xor_b32 s25, s25, 32768
    buffer_load_dwordx4 v[140:143], v1, s[8:11], s25 offen sc1
    s_add_u32 s25, s29, 4096
    buffer_load_dwordx4 v[144:147], v1, s[8:11], s25 offen sc1
    s_xor_b32 s25, s25, 32768
    buffer_load_dwordx4 v[148:151], v1, s[8:11], s25 offen sc1
    s_add_u32 s25, s29, 5120
    buffer_load_dwordx4 v[96:99], v1, s[8:11], s25 offen sc1
    s_xor_b32 s25, s25, 32768
    buffer_load_dwordx4 v[100:103], v1, s[8:11], s25 offen sc1
    s_waitcnt vmcnt(0)
    s_setprio 3
    v_max_u32 v153, v128, v132
    v_cmp_eq_u32 vcc, -1, v153
    s_setprio 0
    s_cbranch_vccnz K_c60_retry
    s_branch K_c60_ok
K_c61_wait:
    s_setprio 3
K_c61_sp:
    ds_read_b32 v153, v2 offset:16
    s_waitcnt lgkmcnt(0)
    v_readfirstlane_b32 s33, v153
    s_cmp_ge_u32 s33, 4
    s_cbranch_scc1 K_c61_sp_ok
    s_sleep 1
    s_branch K_c61_sp
K_c61_sp_ok:
    s_setprio 0
K_c61_retry:
    s_cmp_eq_u32 s60, 0
    s_cbranch_scc1 K_c61_ok
    s_sub_u32 s60, s60, 1
    s_sleep 2
    s_nop 0
    s_add_u32 s25, s29, 1024
    buffer_load_dwordx4 v[136:139], v1, s[8:11], s25 offen sc1
    s_xor_b32 s25, s25, 32768
    buffer_load_dwordx4 v[140:143], v1, s[8:11], s25 offen sc1
    s_add_u32 s25, s29, 4096
    buffer_load_dwordx4 v[144:147], v1, s[8:11], s25 offen sc1
    s_xor_b32 s25, s25, 32768
    buffer_load_dwordx4 v[148:151], v1, s[8:11], s25 offen sc1
    s_add_u32 s25, s29, 5120
    buffer_load_dwordx4 v[96:99], v1, s[8:11], s25 offen sc1
    s_xor_b32 s25, s25, 32768
    buffer_load_dwordx4 v[100:103], v1, s[8:11], s25 offen sc1
    s_waitcnt vmcnt(0)
    s_setprio 3
    v_max_u32 v153, v136, v140
    v_cmp_eq_u32 vcc, -1, v153
    s_setprio 0
    s_cbranch_vccnz K_c61_retry
    s_branch K_c61_ok
K_c62_wait:
    s_setprio 3
K_c62_sp:
    ds_read_b32 v153, v2 offset:16
    s_waitcnt lgkmcnt(0)
    v_readfirstlane_b32 s33, v153
    s_cmp_ge_u32 s33, 4
    s_cbranch_scc1 K_c62_sp_ok
    s_sleep 1
    s_branch K_c62_sp
K_c62_sp_ok:
    s_setprio 0
K_c62_retry:
    s_cmp_eq_u32 s60, 0
    s_cbranch_scc1 K_c62_ok
    s_sub_u32 s60, s60, 1
    s_sleep 2
    s_nop 0
    s_add_u32 s25, s29, 4096
    buffer_load_dwordx4 v[144:147], v1, s[8:11], s25 offen sc1
    s_xor_b32 s25, s25, 32768
    buffer_load_dwordx4 v[148:151], v1, s[8:11], s25 offen sc1
    s_add_u32 s25, s29, 5120
    buffer_load_dwordx4 v[96:99], v1, s[8:11], s25 offen sc1
    s_xor_b32 s25, s25, 32768
    buffer_load_dwordx4 v[100:103], v1, s[8:11], s25 offen sc1
    s_waitcnt vmcnt(0)
    s_setprio 3
    v_max_u32 v153, v144, v148
    v_cmp_eq_u32 vcc, -1, v153
    s_setprio 0
    s_cbranch_vccnz K_c62_retry
    s_branch K_c62_ok
K_c63_wait:
    s_setprio 3
K_c63_sp:
    ds_read_b32 v153, v2 offset:16
    s_waitcnt lgkmcnt(0)
    v_readfirstlane_b32 s33, v153
    s_cmp_ge_u32 s33, 4
    s_cbranch_scc1 K_c63_sp_ok
    s_sleep 1
    s_branch K_c63_sp
K_c63_sp_ok:
    s_setprio 0
K_c63_retry:
    s_cmp_eq_u32 s60, 0
    s_cbranch_scc1 K_c63_ok
    s_sub_u32 s60, s60, 1
    s_sleep 2
    s_add_u32 s25, s29, 5120
    buffer_load_dwordx4 v[96:99], v1, s[8:11], s25 offen sc1
    s_xor_b32 s25, s25, 32768
    buffer_load_dwordx4 v[100:103], v1, s[8:11], s25 offen sc1
    s_waitcnt vmcnt(0)
    s_setprio 3
    v_max_u32 v153, v96, v100
    v_cmp_eq_u32 vcc, -1, v153
    s_setprio 0
    s_cbranch_vccnz K_c63_retry
    s_branch K_c63_ok
K_c64_wait:
    s_setprio 3
K_c64_sp:
    ds_read_b32 v153, v2 offset:20
    s_waitcnt lgkmcnt(0)
    v_readfirstlane_b32 s33, v153
    s_cmp_ge_u32 s33, 4
    s_cbranch_scc1 K_c64_sp_ok
    s_sleep 1
    s_branch K_c64_sp
K_c64_sp_ok:
    s_setprio 0
K_c64_retry:
    s_cmp_eq_u32 s60, 0
    s_cbranch_scc1 K_c64_ok
    s_sub_u32 s60, s60, 1
    s_sleep 2
    s_add_u32 s25, s29, 2048
    buffer_load_dwordx4 v[104:107], v1, s[8:11], s25 offen sc1
    s_xor_b32 s25, s25, 32768
    buffer_load_dwordx4 v[108:111], v1, s[8:11], s25 offen sc1
    s_add_u32 s25, s29, 3072
    buffer_load_dwordx4 v[112:115], v1, s[8:11], s25 offen sc1
    s_xor_b32 s25, s25, 32768
    buffer_load_dwordx4 v[116:119], v1, s[8:11], s25 offen sc1
    s_add_u32 s25, s29, 6144
    buffer_load_dwordx4 v[120:123], v1, s[8:11], s25 offen sc1
    s_xor_b32 s25, s25, 32768
    buffer_load_dwordx4 v[124:127], v1, s[8:11], s25 offen sc1
    s_add_u32 s25, s29, 7168
    buffer_load_dwordx4 v[128:131], v1, s[8:11], s25 offen sc1
    s_xor_b32 s25, s25, 32768
    buffer_load_dwordx4 v[132:135], v1, s[8:11], s25 offen sc1
    s_waitcnt vmcnt(0)
    s_setprio 3
    v_max_u32 v153, v104, v108
    v_max3_u32 v153, v153, v112, v116
    v_max3_u32 v153, v153, v120, v124
    v_max3_u32 v153, v153, v128, v132
    v_cmp_eq_u32 vcc, -1, v153
    s_setprio 0
    s_cbranch_vccnz K_c64_retry
    s_branch K_c64_ok
K_last:
    s_endpgm
.section .rodata,"a"
.p2align 6
.amdhsa_kernel gated_mix__grouped_kv_mqa__mixer_token_mlp__prompt_kernel
  .amdhsa_next_free_vgpr 168
  .amdhsa_next_free_sgpr 80
  .amdhsa_accum_offset 168
  .amdhsa_group_segment_fixed_size 0
  .amdhsa_kernarg_size 112
  .amdhsa_user_sgpr_count 2
  .amdhsa_user_sgpr_kernarg_segment_ptr 1
  .amdhsa_system_sgpr_workgroup_id_x 1
.end_amdhsa_kernel
```
